```python
import torch

def _softmax(x, axis=-1):
    return torch.softmax(x, dim=axis)
def _gelu(x):
    return torch.nn.functional.gelu(x, approximate="tanh")
def _silu(x):
    return torch.nn.functional.silu(x)
def _sigmoid(x):
    return torch.sigmoid(x)
def _layernorm(x, axis=-1, eps=1e-5):
    m = x.mean(dim=axis, keepdim=True)
    v = x.var(dim=axis, keepdim=True, unbiased=False)
    return (x - m) / torch.sqrt(v + eps)
def _scatter_add(tgt, idx, src, axis=0):
    return tgt.clone().index_add_(axis, idx, src)
def _segment_sum(src, seg, n):
    out = torch.zeros((n,) + src.shape[1:], dtype=src.dtype)
    return out.index_add_(0, seg, src)
def _pad(x, pw):
    flat = tuple(v for pair in reversed(pw) for v in pair)
    return torch.nn.functional.pad(x, flat)

kernel_name = 'interleave_layers__mha_block_cached__glu_gated_geglu__decode'

def setup_inputs():

    _w = (lambda a: (lambda t: t.to(torch.bfloat16) if t.is_floating_point() else t)(torch.as_tensor(a)))
    def _A_setup():
        B, Sq, D = 2, 1, 512
        H, Sk, Dh = 32, 8192, 128
        return {
            "x": _w((lambda *s: torch.randn(*s, dtype=torch.bfloat16) * 0.05)(B, Sq, D)),
            "k_cache": _w((lambda *s: torch.randn(*s, dtype=torch.bfloat16) * 0.8)(B, H, Sk, Dh)),
            "v_cache": _w((lambda *s: torch.randn(*s, dtype=torch.bfloat16) * 1.6)(B, H, Sk, Dh)),
            "wq": _w((lambda *s: torch.randn(*s, dtype=torch.bfloat16) * 0.8)(D, H * Dh) * (D ** -0.5)),
            "wo": _w((lambda *s: torch.randn(*s, dtype=torch.bfloat16) * 1.6)(H * Dh, D) * ((H * Dh) ** -0.5)),
        }
    _A_in = _A_setup()

    def _B_setup():
        B, S, Dm, Df = 2, 1, 512, 1792
        return {
            "x": _w((lambda *s: torch.randn(*s, dtype=torch.bfloat16) * 0.05)(B, S, Dm)),
            "w_gate": _w((lambda *s: torch.randn(*s, dtype=torch.bfloat16) * 0.4)(Dm, Df) * (Dm ** -0.5)),
            "w_up": _w((lambda *s: torch.randn(*s, dtype=torch.bfloat16) * 0.4)(Dm, Df) * (Dm ** -0.5)),
            "w_down": _w((lambda *s: torch.randn(*s, dtype=torch.bfloat16) * 0.4)(Df, Dm) * (Df ** -0.5)),
        }
    _B_in = _B_setup()

    return {
        "A_x": _A_in["x"],
        "A_k_cache": _A_in["k_cache"],
        "A_v_cache": _A_in["v_cache"],
        "A_wq": _A_in["wq"],
        "A_wo": _A_in["wo"],
        "B_x": _B_in["x"],
        "B_w_gate": _B_in["w_gate"],
        "B_w_up": _B_in["w_up"],
        "B_w_down": _B_in["w_down"],
    }

def reference(A_x, A_k_cache, A_v_cache, A_wq, A_wo, B_x, B_w_gate, B_w_up, B_w_down):
    def _A_ref(x, k_cache, v_cache, wq, wo):
        B, Sq, D = x.shape
        H, Dh = 32, 128
        q = (lambda x, *d: x.permute(*d))((x @ wq).reshape(B, Sq, H, Dh), 0, 2, 1, 3)
        scores = torch.einsum("bhqd,bhkd->bhqk", q, k_cache) * (Dh ** -0.5)
        p = _softmax(scores, axis=-1)
        o = torch.einsum("bhqk,bhkd->bhqd", p, v_cache)
        return (lambda x, *d: x.permute(*d))(o, 0, 2, 1, 3).reshape(B, Sq, H * Dh) @ wo

    def _B_ref(x, w_gate, w_up, w_down):
        g = torch.einsum("bsd,df->bsf", x, w_gate)
        u = torch.einsum("bsd,df->bsf", x, w_up)
        h = _gelu(g) * u
        return torch.einsum("bsf,fd->bsd", h, w_down)

    x = A_x
    x = x + _A_ref(_layernorm(x, axis=-1), A_k_cache, A_v_cache, A_wq, A_wo)
    x = x + _B_ref(_layernorm(x, axis=-1), B_w_gate, B_w_up, B_w_down)
    x = x + _A_ref(_layernorm(x, axis=-1), A_k_cache, A_v_cache, A_wq, A_wo)
    x = x + _B_ref(_layernorm(x, axis=-1), B_w_gate, B_w_up, B_w_down)
    return x
```

```asm
; @launch grid=(256,1,1) block=(256,1,1) lds=163840
.amdgcn_target "amdgcn-amd-amdhsa--gfx950"
.text
.globl interleave_layers__mha_block_cached__glu_gated_geglu__decode_kernel
.p2align 8
.type interleave_layers__mha_block_cached__glu_gated_geglu__decode_kernel,@function
interleave_layers__mha_block_cached__glu_gated_geglu__decode_kernel:
  s_cmp_ge_u32 s2, 256
  s_cbranch_scc1 L_end
  s_load_dwordx16 s[64:79], s[0:1], 0
  s_load_dwordx8 s[80:87], s[0:1], 64
  v_lshrrev_b32 v1, 6, v0
  v_and_b32 v0, 63, v0
  v_readfirstlane_b32 s3, v1
  v_lshlrev_b32 v2, 4, v0
  v_bfe_u32 v3, v0, 0, 1
  v_lshlrev_b32 v1, 4, v3
  v_bfe_u32 v3, v0, 4, 2
  v_lshl_add_u32 v1, v3, 5, v1
  v_bfe_u32 v3, v0, 1, 2
  v_lshl_add_u32 v1, v3, 8, v1
  v_bfe_u32 v3, v0, 3, 1
  v_lshl_add_u32 v1, v3, 14, v1
  s_sub_u32 s36, s2, 32
  s_and_b32 s37, s36, 31
  s_lshr_b32 s38, s36, 5
  s_lshl_b32 s28, s37, 21
  s_mul_i32 s39, s38, 294912
  s_add_u32 s28, s28, s39
  s_lshl_b32 s39, s3, 12
  s_add_u32 s28, s28, s39
  s_mul_i32 s34, s3, 40960
  s_waitcnt lgkmcnt(0)
  s_mov_b32 s8, s66
  s_mov_b32 s9, s67
  s_mov_b32 s10, 0x8000000
  s_mov_b32 s11, 0x20000
  s_cmp_lt_u32 s2, 32
  s_cbranch_scc1 L_svc
  s_add_u32 s29, s28, 0x0
  buffer_load_dwordx4 a[0:3], v1, s[8:11], s29 offen offset:0 nt
  buffer_load_dwordx4 a[4:7], v1, s[8:11], s29 offen offset:128 nt
  buffer_load_dwordx4 a[8:11], v1, s[8:11], s29 offen offset:1024 nt
  buffer_load_dwordx4 a[12:15], v1, s[8:11], s29 offen offset:1152 nt
  s_mov_b32 s92, 0
  s_mov_b32 s12, s68
  s_mov_b32 s13, s69
  s_mov_b32 s14, 0x8000000
  s_mov_b32 s15, 0x20000
  s_mov_b32 s16, s86
  s_mov_b32 s17, s87
  s_mov_b32 s18, 0x800000
  s_mov_b32 s19, 0x20000
  s_mov_b32 s20, s84
  s_mov_b32 s21, s85
  s_mov_b32 s22, 0x100
  s_mov_b32 s23, 0x20000
  s_mov_b32 s52, 0xf000f
  s_mov_b32 s53, 0xf000f
  s_mov_b32 s54, 0xf000f0
  s_mov_b32 s55, 0xf000f0
  s_mov_b32 s56, 0xf000f00
  s_mov_b32 s57, 0xf000f00
  s_mov_b32 s58, 0xf000f000
  s_mov_b32 s59, 0xf000f000
  s_mov_b32 s60, 0x3e0293ee
  s_mov_b32 s96, 0xaaaaaaaa
  s_mov_b32 s97, 0xaaaaaaaa
  s_mov_b32 s40, s86
  s_mov_b32 s41, s87
  s_mov_b32 s42, 0x0
  s_mov_b32 s43, 0x20000
  s_mov_b32 s44, s86
  s_mov_b32 s45, s87
  s_mov_b32 s46, 0x800000
  s_mov_b32 s47, 0x20000
  s_getreg_b32 s93, hwreg(HW_REG_XCC_ID, 0, 3)
  s_mov_b32 s48, s86
  s_mov_b32 s49, s87
  s_mov_b32 s50, 0x0
  s_mov_b32 s51, 0x20000
  s_cmp_eq_u32 s3, 0
  s_cselect_b32 s50, 0x800000, 0
  s_lshl_b32 s93, s93, 13
  s_add_u32 s93, s93, 0x720000
  s_getreg_b32 s69, hwreg(HW_REG_HW_ID, 8, 1)
  s_lshl_b32 s69, s69, 6
  s_add_u32 s69, s69, s93
  v_mov_b64 v[24:25], 0
  v_mov_b64 v[26:27], 0
  s_lshl_b32 s68, s3, 11
  s_add_u32 s68, s68, s93
  buffer_store_dwordx4 v[24:27], v2, s[16:19], s68 offen offset:0
  buffer_store_dwordx4 v[24:27], v2, s[16:19], s68 offen offset:1024
  s_getreg_b32 s68, hwreg(HW_REG_HW_ID, 13, 2)
  s_getreg_b32 s67, hwreg(HW_REG_HW_ID, 8, 3)
  s_lshl3_add_u32 s68, s68, s67
  s_add_u32 s93, s93, s68
  s_sub_u32 s93, s93, 64
  s_mov_b32 s68, 5
  s_mov_b32 s94, 0
  v_bfe_u32 v36, v0, 0, 3
  v_lshlrev_b32 v52, 4, v36
  v_bfe_u32 v36, v0, 4, 1
  v_lshl_add_u32 v52, v36, 8, v52
  v_bfe_u32 v36, v0, 3, 1
  v_lshl_add_u32 v52, v36, 9, v52
  v_bfe_u32 v36, v0, 5, 1
  v_lshl_add_u32 v52, v36, 10, v52
  v_add_u32 v3, s34, v2
  v_bfe_u32 v36, v0, 4, 2
  v_lshlrev_b32 v4, 6, v36
  v_bfe_u32 v36, v0, 0, 2
  v_lshl_add_u32 v4, v36, 4, v4
  v_and_b32 v36, 3, v0
  v_mul_u32_u24 v53, 0x5555, v36
  v_bfe_u32 v36, v0, 1, 1
  v_mul_u32_u24 v36, 0xaaaa, v36
  v_add_u32 v36, 0x4444, v36
  v_lshl_add_u32 v53, v36, 16, v53
  s_lshl2_add_u32 s24, s38, s3
  s_mul_i32 s24, s24, -224
  s_add_u32 s24, s24, 8192
  v_lshlrev_b32 v32, 22, v2
  v_lshrrev_b32 v33, 5, v2
  v_and_b32 v32, 0x3c000000, v32
  v_add3_u32 v32, v32, v33, s24
  v_lshrrev_b32 v36, 3, v0
  v_and_b32 v36, 6, v36
  v_xor_b32 v36, v36, v0
  v_bfe_u32 v37, v36, 0, 3
  v_lshlrev_b32 v55, 4, v37
  v_bfe_u32 v37, v36, 3, 2
  v_lshl_add_u32 v55, v37, 8, v55
  v_bfe_u32 v37, v36, 5, 1
  v_lshl_add_u32 v55, v37, 14, v55
  v_lshlrev_b32 v36, 2, v0
  v_and_b32 v36, 0x30, v36
  v_xor_b32 v36, v36, v0
  v_bfe_u32 v37, v36, 1, 3
  v_lshl_add_u32 v57, v37, 7, s34
  v_bfe_u32 v37, v36, 4, 2
  v_lshl_add_u32 v57, v37, 5, v57
  v_bfe_u32 v37, v36, 0, 1
  v_lshl_add_u32 v57, v37, 4, v57
  s_lshl_b32 s39, s38, 2
  s_add_u32 s39, s39, s3
  s_lshl_b32 s32, s37, 6
  s_add_u32 s32, s32, s39
  s_lshl_b32 s32, s32, 8
  s_add_u32 s32, s32, 0x100000
  s_lshl_b32 s33, s37, 8
  s_add_u32 s33, s33, 0x700000
  s_add_u32 s26, s33, 16384
  s_and_b32 s35, s37, 7
  s_lshl_b32 s35, s35, 4
  s_mov_b32 s30, 0
  s_mov_b32 s27, 0
  s_lshl_b32 s70, s37, 21
  s_lshl_b32 s39, s3, 12
  s_add_u32 s70, s70, s39
  s_mov_b32 s39, s38
  s_add_u32 s39, s39, 3
  s_sub_u32 s36, s39, 7
  s_min_u32 s39, s39, s36
  s_mul_i32 s36, s39, 294912
  s_add_u32 s71, s70, s36
  s_add_u32 s39, s39, 3
  s_sub_u32 s36, s39, 7
  s_min_u32 s39, s39, s36
  s_mul_i32 s36, s39, 294912
  s_add_u32 s72, s70, s36
  s_add_u32 s39, s39, 3
  s_sub_u32 s36, s39, 7
  s_min_u32 s39, s39, s36
  s_mul_i32 s36, s39, 294912
  s_add_u32 s73, s70, s36
  s_add_u32 s39, s39, 3
  s_sub_u32 s36, s39, 7
  s_min_u32 s39, s39, s36
  s_mul_i32 s36, s39, 294912
  s_add_u32 s74, s70, s36
  s_add_u32 s39, s39, 3
  s_sub_u32 s36, s39, 7
  s_min_u32 s39, s39, s36
  s_mul_i32 s36, s39, 294912
  s_add_u32 s75, s70, s36
  s_add_u32 s39, s39, 3
  s_sub_u32 s36, s39, 7
  s_min_u32 s39, s39, s36
  s_mul_i32 s36, s39, 294912
  s_add_u32 s76, s70, s36
  s_add_u32 s39, s39, 3
  s_sub_u32 s36, s39, 7
  s_min_u32 s39, s39, s36
  s_mul_i32 s36, s39, 294912
  s_add_u32 s77, s70, s36
  s_add_u32 s39, s39, 3
  s_sub_u32 s36, s39, 7
  s_min_u32 s39, s39, s36
  s_mul_i32 s36, s39, 294912
  s_add_u32 s78, s70, s36
  s_getreg_b32 s31, hwreg(HW_REG_XCC_ID, 0, 4)
  s_add_u32 s31, s31, 1
  v_mov_b32 v24, -1
  v_mov_b32 v25, -1
  v_lshrrev_b32 v27, 2, v2
  s_add_u32 s29, s28, 0x800
  buffer_load_dwordx4 a[32:35], v1, s[8:11], s29 offen offset:0 nt
  buffer_load_dwordx4 a[36:39], v1, s[8:11], s29 offen offset:128 nt
  s_waitcnt vmcnt(7)
  buffer_load_dwordx4 a[40:43], v1, s[8:11], s29 offen offset:1024 nt
  s_waitcnt vmcnt(7)
  buffer_load_dwordx4 a[44:47], v1, s[8:11], s29 offen offset:1152 nt
  s_waitcnt vmcnt(7)
  s_add_u32 s29, s71, 0x8000
  s_add_u32 m0, s34, 0
  s_nop 0
  buffer_load_dwordx4 v55, s[8:11], s29 offen offset:0 nt lds
  s_waitcnt vmcnt(7)
  s_add_u32 m0, s34, 896
  s_nop 0
  buffer_load_dwordx4 v55, s[8:11], s29 offen offset:128 nt lds
  s_waitcnt vmcnt(5)
  s_add_u32 m0, s34, 1024
  s_nop 0
  buffer_load_dwordx4 v55, s[8:11], s29 offen offset:1024 nt lds
  s_waitcnt vmcnt(5)
  s_add_u32 m0, s34, 1920
  s_nop 0
  buffer_load_dwordx4 v55, s[8:11], s29 offen offset:1152 nt lds
  s_waitcnt vmcnt(4)
  s_add_u32 s29, s71, 0x8800
  buffer_load_dwordx4 a[64:67], v1, s[8:11], s29 offen offset:0 nt
  s_waitcnt vmcnt(4)
  buffer_load_dwordx4 a[68:71], v1, s[8:11], s29 offen offset:128 nt
  s_waitcnt vmcnt(4)
  buffer_load_dwordx4 a[72:75], v1, s[8:11], s29 offen offset:1024 nt
  s_waitcnt vmcnt(4)
  buffer_load_dwordx4 a[76:79], v1, s[8:11], s29 offen offset:1152 nt
  s_waitcnt vmcnt(4)
  s_add_u32 s29, s72, 0x10000
  s_add_u32 m0, s34, 8192
  s_nop 0
  buffer_load_dwordx4 v55, s[8:11], s29 offen offset:0 nt lds
  s_waitcnt vmcnt(4)
  s_add_u32 m0, s34, 9088
  s_nop 0
  buffer_load_dwordx4 v55, s[8:11], s29 offen offset:128 nt lds
  s_waitcnt vmcnt(4)
  s_add_u32 m0, s34, 9216
  s_nop 0
  buffer_load_dwordx4 v55, s[8:11], s29 offen offset:1024 nt lds
  s_waitcnt vmcnt(4)
  s_add_u32 m0, s34, 10112
  s_nop 0
  buffer_load_dwordx4 v55, s[8:11], s29 offen offset:1152 nt lds
  s_waitcnt vmcnt(4)
  s_add_u32 s29, s72, 0x10800
  buffer_load_dwordx4 a[96:99], v1, s[8:11], s29 offen offset:0 nt
  s_waitcnt vmcnt(4)
  buffer_load_dwordx4 a[100:103], v1, s[8:11], s29 offen offset:128 nt
  s_waitcnt vmcnt(4)
  buffer_load_dwordx4 a[104:107], v1, s[8:11], s29 offen offset:1024 nt
  s_waitcnt vmcnt(4)
  buffer_load_dwordx4 a[108:111], v1, s[8:11], s29 offen offset:1152 nt
  s_waitcnt vmcnt(4)
  s_add_u32 s29, s73, 0x18000
  s_add_u32 m0, s34, 16384
  s_nop 0
  buffer_load_dwordx4 v55, s[8:11], s29 offen offset:0 nt lds
  s_waitcnt vmcnt(4)
  s_add_u32 m0, s34, 17280
  s_nop 0
  buffer_load_dwordx4 v55, s[8:11], s29 offen offset:128 nt lds
  s_waitcnt vmcnt(4)
  s_add_u32 m0, s34, 17408
  s_nop 0
  buffer_load_dwordx4 v55, s[8:11], s29 offen offset:1024 nt lds
  s_waitcnt vmcnt(4)
  s_add_u32 m0, s34, 18304
  s_nop 0
  buffer_load_dwordx4 v55, s[8:11], s29 offen offset:1152 nt lds
  s_waitcnt vmcnt(4)
  s_add_u32 s29, s73, 0x18800
  buffer_load_dwordx4 a[128:131], v1, s[8:11], s29 offen offset:0 nt
  s_waitcnt vmcnt(4)
  buffer_load_dwordx4 a[132:135], v1, s[8:11], s29 offen offset:128 nt
  s_waitcnt vmcnt(4)
  buffer_load_dwordx4 a[136:139], v1, s[8:11], s29 offen offset:1024 nt
  s_waitcnt vmcnt(4)
  buffer_load_dwordx4 a[140:143], v1, s[8:11], s29 offen offset:1152 nt
  s_waitcnt vmcnt(4)
  s_add_u32 s29, s74, 0x20000
  s_add_u32 m0, s34, 24576
  s_nop 0
  buffer_load_dwordx4 v55, s[8:11], s29 offen offset:0 nt lds
  s_waitcnt vmcnt(4)
  s_add_u32 m0, s34, 25472
  s_nop 0
  buffer_load_dwordx4 v55, s[8:11], s29 offen offset:128 nt lds
  s_waitcnt vmcnt(4)
  s_add_u32 m0, s34, 25600
  s_nop 0
  buffer_load_dwordx4 v55, s[8:11], s29 offen offset:1024 nt lds
  s_waitcnt vmcnt(4)
  s_add_u32 m0, s34, 26496
  s_nop 0
  buffer_load_dwordx4 v55, s[8:11], s29 offen offset:1152 nt lds
  s_waitcnt vmcnt(4)
  s_add_u32 s29, s74, 0x20800
  buffer_load_dwordx4 a[160:163], v1, s[8:11], s29 offen offset:0 nt
  s_waitcnt vmcnt(4)
  buffer_load_dwordx4 a[164:167], v1, s[8:11], s29 offen offset:128 nt
  s_waitcnt vmcnt(4)
  buffer_load_dwordx4 a[168:171], v1, s[8:11], s29 offen offset:1024 nt
  s_waitcnt vmcnt(4)
  buffer_load_dwordx4 a[172:175], v1, s[8:11], s29 offen offset:1152 nt
  s_waitcnt vmcnt(4)
  s_add_u32 s29, s75, 0x28000
  buffer_load_dwordx4 a[192:195], v1, s[8:11], s29 offen offset:0 nt
  s_waitcnt vmcnt(4)
  buffer_load_dwordx4 a[196:199], v1, s[8:11], s29 offen offset:128 nt
  s_waitcnt vmcnt(4)
  buffer_load_dwordx4 a[200:203], v1, s[8:11], s29 offen offset:1024 nt
  s_waitcnt vmcnt(4)
  buffer_load_dwordx4 a[204:207], v1, s[8:11], s29 offen offset:1152 nt
  s_waitcnt vmcnt(4)
  s_add_u32 s29, s75, 0x28800
  buffer_load_dwordx4 a[224:227], v1, s[8:11], s29 offen offset:0 nt
  s_waitcnt vmcnt(4)
  buffer_load_dwordx4 a[228:231], v1, s[8:11], s29 offen offset:128 nt
  s_waitcnt vmcnt(4)
  buffer_load_dwordx4 a[232:235], v1, s[8:11], s29 offen offset:1024 nt
  s_waitcnt vmcnt(4)
  buffer_load_dwordx4 a[236:239], v1, s[8:11], s29 offen offset:1152 nt
  s_waitcnt vmcnt(4)
  s_add_u32 s29, s76, 0x30000
  buffer_load_dwordx4 v[64:67], v1, s[8:11], s29 offen offset:0 nt
  s_waitcnt vmcnt(4)
  buffer_load_dwordx4 v[68:71], v1, s[8:11], s29 offen offset:128 nt
  s_waitcnt vmcnt(4)
  buffer_load_dwordx4 v[72:75], v1, s[8:11], s29 offen offset:1024 nt
  s_waitcnt vmcnt(4)
  buffer_load_dwordx4 v[76:79], v1, s[8:11], s29 offen offset:1152 nt
  s_waitcnt vmcnt(4)
  s_add_u32 s29, s76, 0x30800
  buffer_load_dwordx4 v[96:99], v1, s[8:11], s29 offen offset:0 nt
  s_waitcnt vmcnt(4)
  buffer_load_dwordx4 v[100:103], v1, s[8:11], s29 offen offset:128 nt
  s_waitcnt vmcnt(4)
  buffer_load_dwordx4 v[104:107], v1, s[8:11], s29 offen offset:1024 nt
  s_waitcnt vmcnt(4)
  buffer_load_dwordx4 v[108:111], v1, s[8:11], s29 offen offset:1152 nt
  s_waitcnt vmcnt(4)
  s_add_u32 s29, s77, 0x38000
  buffer_load_dwordx4 v[128:131], v1, s[8:11], s29 offen offset:0 nt
  s_waitcnt vmcnt(4)
  buffer_load_dwordx4 v[132:135], v1, s[8:11], s29 offen offset:128 nt
  s_waitcnt vmcnt(4)
  buffer_load_dwordx4 v[136:139], v1, s[8:11], s29 offen offset:1024 nt
  s_waitcnt vmcnt(4)
  buffer_load_dwordx4 v[140:143], v1, s[8:11], s29 offen offset:1152 nt
  s_waitcnt vmcnt(4)
  s_add_u32 s29, s77, 0x38800
  buffer_load_dwordx4 v[160:163], v1, s[8:11], s29 offen offset:0 nt
  s_waitcnt vmcnt(4)
  buffer_load_dwordx4 v[164:167], v1, s[8:11], s29 offen offset:128 nt
  s_waitcnt vmcnt(4)
  buffer_load_dwordx4 v[168:171], v1, s[8:11], s29 offen offset:1024 nt
  s_waitcnt vmcnt(4)
  buffer_load_dwordx4 v[172:175], v1, s[8:11], s29 offen offset:1152 nt
  s_waitcnt vmcnt(4)
  s_add_u32 s29, s78, 0x40000
  buffer_load_dwordx4 v[192:195], v1, s[8:11], s29 offen offset:0 nt
  s_waitcnt vmcnt(4)
  buffer_load_dwordx4 v[196:199], v1, s[8:11], s29 offen offset:128 nt
  s_waitcnt vmcnt(4)
  buffer_load_dwordx4 v[200:203], v1, s[8:11], s29 offen offset:1024 nt
  s_waitcnt vmcnt(4)
  buffer_load_dwordx4 v[204:207], v1, s[8:11], s29 offen offset:1152 nt
  s_waitcnt vmcnt(4)
  s_add_u32 s29, s78, 0x40800
  buffer_load_dwordx4 v[224:227], v1, s[8:11], s29 offen offset:0 nt
  s_waitcnt vmcnt(4)
  buffer_load_dwordx4 v[228:231], v1, s[8:11], s29 offen offset:128 nt
  s_waitcnt vmcnt(4)
  buffer_load_dwordx4 v[232:235], v1, s[8:11], s29 offen offset:1024 nt
  s_waitcnt vmcnt(4)
  buffer_load_dwordx4 v[236:239], v1, s[8:11], s29 offen offset:1152 nt
  s_waitcnt vmcnt(4)
  s_add_u32 s29, s28, 0x0
  buffer_load_dwordx4 a[16:19], v52, s[12:15], s29 offen offset:0 nt
  s_waitcnt vmcnt(4)
  buffer_load_dwordx4 a[20:23], v52, s[12:15], s29 offen offset:2048 nt
  s_waitcnt vmcnt(4)
  buffer_load_dwordx4 a[24:27], v52, s[12:15], s29 offen offset:128 nt
  s_waitcnt vmcnt(4)
  buffer_load_dwordx4 a[28:31], v52, s[12:15], s29 offen offset:2176 nt
  s_waitcnt vmcnt(4)
  s_add_u32 s29, s28, 0x4000
  buffer_load_dwordx4 a[48:51], v52, s[12:15], s29 offen offset:0 nt
  s_waitcnt vmcnt(4)
  buffer_load_dwordx4 a[52:55], v52, s[12:15], s29 offen offset:2048 nt
  s_waitcnt vmcnt(4)
  buffer_load_dwordx4 a[56:59], v52, s[12:15], s29 offen offset:128 nt
  s_waitcnt vmcnt(4)
  buffer_load_dwordx4 a[60:63], v52, s[12:15], s29 offen offset:2176 nt
  s_buffer_load_dwordx8 s[80:87], s[16:19], s69 offset:896
  s_mov_b64 exec, 0x110
  s_cmp_eq_u32 s3, 2
  s_cselect_b32 s50, 0x800000, 0
  buffer_store_byte v2, v2, s[48:51], s93 offen offset:768
  s_mov_b64 exec, -1
  s_cmp_gt_i32 s92, 0
  s_cbranch_scc1 L_d_1
  s_waitcnt vmcnt(5)
L_d_1:
  s_add_u32 s29, s71, 0x8000
  s_add_u32 m0, s34, 4096
  s_nop 0
  buffer_load_dwordx4 v52, s[12:15], s29 offen offset:0 nt lds
  s_cmp_gt_i32 s92, 0
  s_cbranch_scc1 L_d_2
  s_waitcnt vmcnt(5)
L_d_2:
  s_add_u32 m0, s34, 3072
  s_nop 0
  buffer_load_dwordx4 v52, s[12:15], s29 offen offset:2048 nt lds
  s_cmp_gt_i32 s92, 0
  s_cbranch_scc1 L_d_3
  s_waitcnt vmcnt(5)
L_d_3:
  s_add_u32 m0, s34, 6016
  s_nop 0
  buffer_load_dwordx4 v52, s[12:15], s29 offen offset:128 nt lds
  s_cmp_gt_i32 s92, 0
  s_cbranch_scc1 L_d_4
  s_waitcnt vmcnt(5)
L_d_4:
  s_add_u32 m0, s34, 4992
  s_nop 0
  buffer_load_dwordx4 v52, s[12:15], s29 offen offset:2176 nt lds
  s_waitcnt lgkmcnt(0)
  s_bcnt1_i32_b64 s80, s[80:81]
  s_bcnt1_i32_b64 s81, s[82:83]
  s_bcnt1_i32_b64 s82, s[84:85]
  s_bcnt1_i32_b64 s83, s[86:87]
  s_add_u32 s80, s80, s81
  s_add_u32 s82, s82, s83
  s_add_u32 s80, s80, s82
  s_cmp_ge_u32 s80, s68
  s_cselect_b32 s80, 6, 0
  s_sub_u32 s92, s92, 1
  s_cselect_b32 s92, s80, s92
  s_buffer_load_dwordx8 s[80:87], s[16:19], s69 offset:1024
  s_mov_b64 exec, 0x110
  s_cmp_eq_u32 s3, 3
  s_cselect_b32 s50, 0x800000, 0
  buffer_store_byte v2, v2, s[48:51], s93 offen offset:896
  s_mov_b64 exec, -1
  s_waitcnt vmcnt(10)
  s_cmp_gt_i32 s92, 0
  s_cbranch_scc1 L_d_5
  s_waitcnt vmcnt(6)
L_d_5:
  s_add_u32 s29, s71, 0xc000
  buffer_load_dwordx4 a[80:83], v52, s[12:15], s29 offen offset:0 nt
  s_waitcnt vmcnt(10)
  s_cmp_gt_i32 s92, 0
  s_cbranch_scc1 L_d_6
  s_waitcnt vmcnt(5)
L_d_6:
  buffer_load_dwordx4 a[84:87], v52, s[12:15], s29 offen offset:2048 nt
  s_waitcnt vmcnt(10)
  s_cmp_gt_i32 s92, 0
  s_cbranch_scc1 L_d_7
  s_waitcnt vmcnt(5)
L_d_7:
  buffer_load_dwordx4 a[88:91], v52, s[12:15], s29 offen offset:128 nt
  s_waitcnt vmcnt(10)
  s_cmp_gt_i32 s92, 0
  s_cbranch_scc1 L_d_8
  s_waitcnt vmcnt(5)
L_d_8:
  buffer_load_dwordx4 a[92:95], v52, s[12:15], s29 offen offset:2176 nt
  buffer_load_dwordx4 v[36:39], off, s[20:23], s35
  s_waitcnt lgkmcnt(0)
  s_bcnt1_i32_b64 s80, s[80:81]
  s_bcnt1_i32_b64 s81, s[82:83]
  s_bcnt1_i32_b64 s82, s[84:85]
  s_bcnt1_i32_b64 s83, s[86:87]
  s_add_u32 s80, s80, s81
  s_add_u32 s82, s82, s83
  s_add_u32 s80, s80, s82
  s_cmp_ge_u32 s80, s68
  s_cselect_b32 s80, 6, 0
  s_sub_u32 s92, s92, 1
  s_cselect_b32 s92, s80, s92
  s_buffer_load_dwordx8 s[80:87], s[16:19], s69 offset:1152
  s_mov_b64 exec, 0x110
  s_cmp_eq_u32 s3, 0
  s_cselect_b32 s50, 0x800000, 0
  buffer_store_byte v2, v2, s[48:51], s93 offen offset:1024
  s_mov_b64 exec, -1
  s_waitcnt vmcnt(12)
  s_cmp_gt_i32 s92, 0
  s_cbranch_scc1 L_d_9
  s_waitcnt vmcnt(7)
L_d_9:
  s_add_u32 s29, s72, 0x10000
  s_add_u32 m0, s34, 12288
  s_nop 0
  buffer_load_dwordx4 v52, s[12:15], s29 offen offset:0 nt lds
  s_waitcnt vmcnt(11)
  s_cmp_gt_i32 s92, 0
  s_cbranch_scc1 L_d_10
  s_waitcnt vmcnt(6)
L_d_10:
  s_add_u32 m0, s34, 11264
  s_nop 0
  buffer_load_dwordx4 v52, s[12:15], s29 offen offset:2048 nt lds
  s_waitcnt vmcnt(11)
  s_cmp_gt_i32 s92, 0
  s_cbranch_scc1 L_d_11
  s_waitcnt vmcnt(6)
L_d_11:
  s_add_u32 m0, s34, 14208
  s_nop 0
  buffer_load_dwordx4 v52, s[12:15], s29 offen offset:128 nt lds
  s_waitcnt vmcnt(11)
  s_cmp_gt_i32 s92, 0
  s_cbranch_scc1 L_d_12
  s_waitcnt vmcnt(6)
L_d_12:
  s_add_u32 m0, s34, 13184
  s_nop 0
  buffer_load_dwordx4 v52, s[12:15], s29 offen offset:2176 nt lds
  s_waitcnt lgkmcnt(0)
  s_bcnt1_i32_b64 s80, s[80:81]
  s_bcnt1_i32_b64 s81, s[82:83]
  s_bcnt1_i32_b64 s82, s[84:85]
  s_bcnt1_i32_b64 s83, s[86:87]
  s_add_u32 s80, s80, s81
  s_add_u32 s82, s82, s83
  s_add_u32 s80, s80, s82
  s_cmp_ge_u32 s80, s68
  s_cselect_b32 s80, 6, 0
  s_sub_u32 s92, s92, 1
  s_cselect_b32 s92, s80, s92
  s_buffer_load_dwordx8 s[80:87], s[16:19], s69 offset:1280
  s_mov_b64 exec, 0x110
  s_cmp_eq_u32 s3, 1
  s_cselect_b32 s50, 0x800000, 0
  buffer_store_byte v2, v2, s[48:51], s93 offen offset:1152
  s_mov_b64 exec, -1
  s_waitcnt vmcnt(12)
  s_cmp_gt_i32 s92, 0
  s_cbranch_scc1 L_d_13
  s_waitcnt vmcnt(7)
L_d_13:
  s_add_u32 s29, s72, 0x14000
  buffer_load_dwordx4 a[112:115], v52, s[12:15], s29 offen offset:0 nt
  s_waitcnt vmcnt(11)
  s_cmp_gt_i32 s92, 0
  s_cbranch_scc1 L_d_14
  s_waitcnt vmcnt(5)
L_d_14:
  buffer_load_dwordx4 a[116:119], v52, s[12:15], s29 offen offset:2048 nt
  s_waitcnt vmcnt(11)
  s_cmp_gt_i32 s92, 0
  s_cbranch_scc1 L_d_15
  s_waitcnt vmcnt(5)
L_d_15:
  buffer_load_dwordx4 a[120:123], v52, s[12:15], s29 offen offset:128 nt
  s_waitcnt vmcnt(11)
  s_cmp_gt_i32 s92, 0
  s_cbranch_scc1 L_d_16
  s_waitcnt vmcnt(5)
L_d_16:
  buffer_load_dwordx4 a[124:127], v52, s[12:15], s29 offen offset:2176 nt
  s_waitcnt vmcnt(10)
  s_mov_b32 s61, 0
L_flag:
  v_max3_u32 v40, v36, v37, v38
  v_max_u32 v40, v40, v39
  v_min3_u32 v36, v36, v37, v38
  v_min_u32 v36, v36, v39
  s_nop 0
  v_readfirstlane_b32 s36, v36
  s_cmp_lg_u32 s36, 0
  s_nop 2
  s_cbranch_scc1 L_flag_ok
  buffer_load_dwordx4 v[36:39], off, s[20:23], s35 sc1
  s_waitcnt vmcnt(0)
  s_add_u32 s61, s61, 1
  s_cmp_gt_u32 s61, 20000
  s_cbranch_scc1 L_flag_ok
  s_sleep 4
  s_branch L_flag
L_flag_ok:
  v_readfirstlane_b32 s61, v40
  s_cmp_eq_u32 s36, s61
  s_cselect_b32 s36, s36, 0
  s_cmp_eq_u32 s36, s31
  s_cselect_b32 s42, 0x800000, 0
  s_cselect_b32 s46, 0, 0x800000
  s_cselect_b32 s31, 0x10000, 0
  s_add_u32 s36, s32, 0x80000
  buffer_store_dword v24, v27, s[40:43], s36 offen
  buffer_store_dword v24, v27, s[44:47], s36 offen sc1
  buffer_store_dwordx2 v[24:25], v32, s[40:43], s36 offen
  buffer_store_dwordx2 v[24:25], v32, s[44:47], s36 offen sc1
  s_add_u32 s36, s32, 0x100000
  buffer_store_dword v24, v27, s[40:43], s36 offen
  buffer_store_dword v24, v27, s[44:47], s36 offen sc1
  buffer_store_dwordx2 v[24:25], v32, s[40:43], s36 offen
  buffer_store_dwordx2 v[24:25], v32, s[44:47], s36 offen sc1
  s_add_u32 s36, s32, 0x180000
  buffer_store_dword v24, v27, s[40:43], s36 offen
  buffer_store_dword v24, v27, s[44:47], s36 offen sc1
  buffer_store_dwordx2 v[24:25], v32, s[40:43], s36 offen
  buffer_store_dwordx2 v[24:25], v32, s[44:47], s36 offen sc1
  s_waitcnt lgkmcnt(0)
  s_bcnt1_i32_b64 s80, s[80:81]
  s_bcnt1_i32_b64 s81, s[82:83]
  s_bcnt1_i32_b64 s82, s[84:85]
  s_bcnt1_i32_b64 s83, s[86:87]
  s_add_u32 s80, s80, s81
  s_add_u32 s82, s82, s83
  s_add_u32 s80, s80, s82
  s_cmp_ge_u32 s80, s68
  s_cselect_b32 s80, 6, 0
  s_sub_u32 s92, s92, 1
  s_cselect_b32 s92, s80, s92
  s_buffer_load_dwordx8 s[80:87], s[16:19], s69 offset:1408
  s_mov_b64 exec, 0x110
  s_cmp_eq_u32 s3, 2
  s_cselect_b32 s50, 0x800000, 0
  buffer_store_byte v2, v2, s[48:51], s93 offen offset:1280
  s_mov_b64 exec, -1
  s_cmp_gt_i32 s92, 0
  s_cbranch_scc1 L_d_17
  s_waitcnt vmcnt(19)
L_d_17:
  s_add_u32 s29, s73, 0x18000
  s_add_u32 m0, s34, 20480
  s_nop 0
  buffer_load_dwordx4 v52, s[12:15], s29 offen offset:0 nt lds
  s_waitcnt vmcnt(22)
  s_cmp_gt_i32 s92, 0
  s_cbranch_scc1 L_d_18
  s_waitcnt vmcnt(19)
L_d_18:
  s_add_u32 m0, s34, 19456
  s_nop 0
  buffer_load_dwordx4 v52, s[12:15], s29 offen offset:2048 nt lds
  s_waitcnt vmcnt(22)
  s_cmp_gt_i32 s92, 0
  s_cbranch_scc1 L_d_19
  s_waitcnt vmcnt(18)
L_d_19:
  s_add_u32 m0, s34, 22400
  s_nop 0
  buffer_load_dwordx4 v52, s[12:15], s29 offen offset:128 nt lds
  s_waitcnt vmcnt(22)
  s_cmp_gt_i32 s92, 0
  s_cbranch_scc1 L_d_20
  s_waitcnt vmcnt(18)
L_d_20:
  s_add_u32 m0, s34, 21376
  s_nop 0
  buffer_load_dwordx4 v52, s[12:15], s29 offen offset:2176 nt lds
  buffer_load_dwordx4 v[36:39], v4, s[16:19], s33 offen sc1
  buffer_load_dwordx4 v[40:43], v4, s[16:19], s26 offen sc1
  s_waitcnt lgkmcnt(0)
  s_bcnt1_i32_b64 s80, s[80:81]
  s_bcnt1_i32_b64 s81, s[82:83]
  s_bcnt1_i32_b64 s82, s[84:85]
  s_bcnt1_i32_b64 s83, s[86:87]
  s_add_u32 s80, s80, s81
  s_add_u32 s82, s82, s83
  s_add_u32 s80, s80, s82
  s_cmp_ge_u32 s80, s68
  s_cselect_b32 s80, 6, 0
  s_sub_u32 s92, s92, 1
  s_cselect_b32 s92, s80, s92
  s_buffer_load_dwordx8 s[80:87], s[16:19], s69 offset:1536
  s_mov_b64 exec, 0x110
  s_cmp_eq_u32 s3, 3
  s_cselect_b32 s50, 0x800000, 0
  buffer_store_byte v2, v2, s[48:51], s93 offen offset:1408
  s_mov_b64 exec, -1
  s_waitcnt vmcnt(25)
  s_cmp_gt_i32 s92, 0
  s_cbranch_scc1 L_d_21
  s_waitcnt vmcnt(21)
L_d_21:
  s_add_u32 s29, s73, 0x1c000
  buffer_load_dwordx4 a[144:147], v52, s[12:15], s29 offen offset:0 nt
  s_waitcnt vmcnt(24)
  s_cmp_gt_i32 s92, 0
  s_cbranch_scc1 L_d_22
  s_waitcnt vmcnt(21)
L_d_22:
  buffer_load_dwordx4 a[148:151], v52, s[12:15], s29 offen offset:2048 nt
  s_waitcnt vmcnt(24)
  s_cmp_gt_i32 s92, 0
  s_cbranch_scc1 L_d_23
  s_waitcnt vmcnt(8)
L_d_23:
  buffer_load_dwordx4 a[152:155], v52, s[12:15], s29 offen offset:128 nt
  s_waitcnt vmcnt(24)
  s_cmp_gt_i32 s92, 0
  s_cbranch_scc1 L_d_24
  s_waitcnt vmcnt(8)
L_d_24:
  buffer_load_dwordx4 a[156:159], v52, s[12:15], s29 offen offset:2176 nt
  s_waitcnt lgkmcnt(0)
  s_bcnt1_i32_b64 s80, s[80:81]
  s_bcnt1_i32_b64 s81, s[82:83]
  s_bcnt1_i32_b64 s82, s[84:85]
  s_bcnt1_i32_b64 s83, s[86:87]
  s_add_u32 s80, s80, s81
  s_add_u32 s82, s82, s83
  s_add_u32 s80, s80, s82
  s_cmp_ge_u32 s80, s68
  s_cselect_b32 s80, 6, 0
  s_sub_u32 s92, s92, 1
  s_cselect_b32 s92, s80, s92
  s_buffer_load_dwordx8 s[80:87], s[16:19], s69 offset:1664
  s_mov_b64 exec, 0x110
  s_cmp_eq_u32 s3, 0
  s_cselect_b32 s50, 0x800000, 0
  buffer_store_byte v2, v2, s[48:51], s93 offen offset:1536
  s_mov_b64 exec, -1
  s_waitcnt vmcnt(25)
  s_cmp_gt_i32 s92, 0
  s_cbranch_scc1 L_d_25
  s_waitcnt vmcnt(9)
L_d_25:
  s_add_u32 s29, s74, 0x20000
  s_add_u32 m0, s34, 28672
  s_nop 0
  buffer_load_dwordx4 v52, s[12:15], s29 offen offset:0 nt lds
  s_waitcnt vmcnt(12)
  s_cmp_gt_i32 s92, 0
  s_cbranch_scc1 L_d_26
  s_waitcnt vmcnt(9)
L_d_26:
  s_add_u32 m0, s34, 27648
  s_nop 0
  buffer_load_dwordx4 v52, s[12:15], s29 offen offset:2048 nt lds
  s_waitcnt vmcnt(12)
  s_cmp_gt_i32 s92, 0
  s_cbranch_scc1 L_d_27
  s_waitcnt vmcnt(6)
L_d_27:
  s_add_u32 m0, s34, 30592
  s_nop 0
  buffer_load_dwordx4 v52, s[12:15], s29 offen offset:128 nt lds
  s_waitcnt vmcnt(12)
  s_cmp_gt_i32 s92, 0
  s_cbranch_scc1 L_d_28
  s_waitcnt vmcnt(6)
L_d_28:
  s_add_u32 m0, s34, 29568
  s_nop 0
  buffer_load_dwordx4 v52, s[12:15], s29 offen offset:2176 nt lds
  s_waitcnt vmcnt(10)
  s_mov_b32 s61, 0
L_q1:
  v_max3_u32 v24, v36, v37, v38
  v_max3_u32 v24, v24, v39, v40
  v_max3_u32 v24, v24, v41, v42
  v_max_u32 v24, v24, v43
  v_cmp_eq_u32 vcc, -1, v24
  s_nop 0
  s_cbranch_vccz L_q1_ok
  buffer_load_dwordx4 v[36:39], v4, s[16:19], s33 offen sc1
  buffer_load_dwordx4 v[40:43], v4, s[16:19], s26 offen sc1
  s_waitcnt vmcnt(0)
  s_add_u32 s61, s61, 1
  s_cmp_gt_u32 s61, 20000
  s_cbranch_scc1 L_q1_ok
  s_sleep 4
  s_branch L_q1
L_q1_ok:
  v_cndmask_b32 v8, 0, v36, s[52:53]
  v_cndmask_b32 v9, 0, v37, s[52:53]
  v_cndmask_b32 v10, 0, v38, s[52:53]
  v_cndmask_b32 v11, 0, v39, s[52:53]
  v_cndmask_b32 v12, 0, v36, s[54:55]
  v_cndmask_b32 v13, 0, v37, s[54:55]
  v_cndmask_b32 v14, 0, v38, s[54:55]
  v_cndmask_b32 v15, 0, v39, s[54:55]
  v_cndmask_b32 v16, 0, v36, s[56:57]
  v_cndmask_b32 v17, 0, v37, s[56:57]
  v_cndmask_b32 v18, 0, v38, s[56:57]
  v_cndmask_b32 v19, 0, v39, s[56:57]
  v_cndmask_b32 v20, 0, v36, s[58:59]
  v_cndmask_b32 v21, 0, v37, s[58:59]
  v_cndmask_b32 v22, 0, v38, s[58:59]
  v_cndmask_b32 v23, 0, v39, s[58:59]
  s_add_u32 s33, s33, s31
  s_waitcnt lgkmcnt(0)
  s_bcnt1_i32_b64 s80, s[80:81]
  s_bcnt1_i32_b64 s81, s[82:83]
  s_bcnt1_i32_b64 s82, s[84:85]
  s_bcnt1_i32_b64 s83, s[86:87]
  s_add_u32 s80, s80, s81
  s_add_u32 s82, s82, s83
  s_add_u32 s80, s80, s82
  s_cmp_ge_u32 s80, s68
  s_cselect_b32 s80, 6, 0
  s_sub_u32 s92, s92, 1
  s_cselect_b32 s92, s80, s92
  s_buffer_load_dwordx8 s[80:87], s[16:19], s69 offset:1792
  s_mov_b64 exec, 0x110
  s_cmp_eq_u32 s3, 1
  s_cselect_b32 s50, 0x800000, 0
  buffer_store_byte v2, v2, s[48:51], s93 offen offset:1664
  s_mov_b64 exec, -1
  s_cmp_gt_i32 s92, 0
  s_cbranch_scc1 L_d_29
  s_waitcnt vmcnt(7)
L_d_29:
  s_add_u32 s29, s74, 0x24000
  buffer_load_dwordx4 a[176:179], v52, s[12:15], s29 offen offset:0 nt
  s_waitcnt vmcnt(10)
  s_cmp_gt_i32 s92, 0
  s_cbranch_scc1 L_d_30
  s_waitcnt vmcnt(7)
L_d_30:
  buffer_load_dwordx4 a[180:183], v52, s[12:15], s29 offen offset:2048 nt
  s_waitcnt vmcnt(10)
  s_cmp_gt_i32 s92, 0
  s_cbranch_scc1 L_d_31
  s_waitcnt vmcnt(6)
L_d_31:
  buffer_load_dwordx4 a[184:187], v52, s[12:15], s29 offen offset:128 nt
  s_waitcnt vmcnt(10)
  s_cmp_gt_i32 s92, 0
  s_cbranch_scc1 L_d_32
  s_waitcnt vmcnt(6)
L_d_32:
  buffer_load_dwordx4 a[188:191], v52, s[12:15], s29 offen offset:2176 nt
  s_waitcnt lgkmcnt(0)
  s_bcnt1_i32_b64 s80, s[80:81]
  s_bcnt1_i32_b64 s81, s[82:83]
  s_bcnt1_i32_b64 s82, s[84:85]
  s_bcnt1_i32_b64 s83, s[86:87]
  s_add_u32 s80, s80, s81
  s_add_u32 s82, s82, s83
  s_add_u32 s80, s80, s82
  s_cmp_ge_u32 s80, s68
  s_cselect_b32 s80, 6, 0
  s_sub_u32 s92, s92, 1
  s_cselect_b32 s92, s80, s92
  s_buffer_load_dwordx8 s[80:87], s[16:19], s69 offset:1920
  s_mov_b64 exec, 0x110
  s_cmp_eq_u32 s3, 2
  s_cselect_b32 s50, 0x800000, 0
  buffer_store_byte v2, v2, s[48:51], s93 offen offset:1792
  s_mov_b64 exec, -1
  s_waitcnt vmcnt(11)
  s_cmp_gt_i32 s92, 0
  s_cbranch_scc1 L_d_33
  s_waitcnt vmcnt(7)
L_d_33:
  s_add_u32 s29, s75, 0x28000
  buffer_load_dwordx4 a[208:211], v52, s[12:15], s29 offen offset:0 nt
  s_waitcnt vmcnt(10)
  s_cmp_gt_i32 s92, 0
  s_cbranch_scc1 L_d_34
  s_waitcnt vmcnt(7)
L_d_34:
  buffer_load_dwordx4 a[212:215], v52, s[12:15], s29 offen offset:2048 nt
  s_waitcnt vmcnt(10)
  s_cmp_gt_i32 s92, 0
  s_cbranch_scc1 L_d_35
  s_waitcnt vmcnt(6)
L_d_35:
  buffer_load_dwordx4 a[216:219], v52, s[12:15], s29 offen offset:128 nt
  s_waitcnt vmcnt(10)
  s_cmp_gt_i32 s92, 0
  s_cbranch_scc1 L_d_36
  s_waitcnt vmcnt(6)
L_d_36:
  buffer_load_dwordx4 a[220:223], v52, s[12:15], s29 offen offset:2176 nt
  s_waitcnt lgkmcnt(0)
  s_bcnt1_i32_b64 s80, s[80:81]
  s_bcnt1_i32_b64 s81, s[82:83]
  s_bcnt1_i32_b64 s82, s[84:85]
  s_bcnt1_i32_b64 s83, s[86:87]
  s_add_u32 s80, s80, s81
  s_add_u32 s82, s82, s83
  s_add_u32 s80, s80, s82
  s_cmp_ge_u32 s80, s68
  s_cselect_b32 s80, 6, 0
  s_sub_u32 s92, s92, 1
  s_cselect_b32 s92, s80, s92
  s_buffer_load_dwordx8 s[80:87], s[16:19], s69 offset:2048
  s_mov_b64 exec, 0x110
  s_cmp_eq_u32 s3, 3
  s_cselect_b32 s50, 0x800000, 0
  buffer_store_byte v2, v2, s[48:51], s93 offen offset:1920
  s_mov_b64 exec, -1
  s_waitcnt vmcnt(11)
  s_cmp_gt_i32 s92, 0
  s_cbranch_scc1 L_d_37
  s_waitcnt vmcnt(7)
L_d_37:
  s_add_u32 s29, s75, 0x2c000
  buffer_load_dwordx4 a[240:243], v52, s[12:15], s29 offen offset:0 nt
  s_waitcnt vmcnt(10)
  s_cmp_gt_i32 s92, 0
  s_cbranch_scc1 L_d_38
  s_waitcnt vmcnt(7)
L_d_38:
  buffer_load_dwordx4 a[244:247], v52, s[12:15], s29 offen offset:2048 nt
  s_waitcnt vmcnt(10)
  s_cmp_gt_i32 s92, 0
  s_cbranch_scc1 L_d_39
  s_waitcnt vmcnt(6)
L_d_39:
  buffer_load_dwordx4 a[248:251], v52, s[12:15], s29 offen offset:128 nt
  s_waitcnt vmcnt(10)
  s_cmp_gt_i32 s92, 0
  s_cbranch_scc1 L_d_40
  s_waitcnt vmcnt(6)
L_d_40:
  buffer_load_dwordx4 a[252:255], v52, s[12:15], s29 offen offset:2176 nt
L_C1:
  s_waitcnt vmcnt(9)
  s_waitcnt lgkmcnt(0)
  s_bcnt1_i32_b64 s80, s[80:81]
  s_bcnt1_i32_b64 s81, s[82:83]
  s_bcnt1_i32_b64 s82, s[84:85]
  s_bcnt1_i32_b64 s83, s[86:87]
  s_add_u32 s80, s80, s81
  s_add_u32 s82, s82, s83
  s_add_u32 s80, s80, s82
  s_cmp_ge_u32 s80, s68
  s_cselect_b32 s80, 6, 0
  s_sub_u32 s92, s92, 1
  s_cselect_b32 s92, s80, s92
  s_buffer_load_dwordx8 s[80:87], s[16:19], s69 offset:2176
  s_mov_b64 exec, 0x110
  s_cmp_eq_u32 s3, 0
  s_cselect_b32 s50, 0x800000, 0
  buffer_store_byte v2, v2, s[48:51], s93 offen offset:2048
  s_mov_b64 exec, -1
  s_cmp_gt_i32 s92, 0
  s_cbranch_scc1 L_d_41
  s_waitcnt vmcnt(7)
L_d_41:
  s_add_u32 s29, s27, s76
  s_add_u32 s29, s29, 0x30000
  buffer_load_dwordx4 v[80:83], v52, s[12:15], s29 offen offset:0 nt
  v_mov_b32 v5, 0xff800000
  v_mov_b64 v[24:25], 0
  v_mov_b64 v[26:27], 0
  v_mov_b64 v[28:29], 0
  v_mov_b64 v[30:31], 0
  v_mov_b64 v[32:33], 0
  v_mov_b64 v[34:35], 0
  s_cmp_eq_u32 s30, 2
  s_cbranch_scc1 L_qk_skip
  ds_read_b128 v[36:39], v57 offset:0
  ds_read_b128 v[40:43], v57 offset:1024
  ds_read_b128 v[44:47], v57 offset:2048
  ds_read_b128 v[48:51], v57 offset:3072
  v_smfmac_f32_16x16x64_bf16 v[24:27], v[8:11], a[0:7], v53 abid:1
  v_smfmac_f32_16x16x64_bf16 v[24:27], v[12:15], a[8:15], v53 abid:1
  v_smfmac_f32_16x16x64_bf16 v[24:27], v[16:19], a[32:39], v53 abid:1
  v_smfmac_f32_16x16x64_bf16 v[24:27], v[20:23], a[40:47], v53 abid:1
  s_waitcnt lgkmcnt(2)
  v_smfmac_f32_16x16x64_bf16 v[28:31], v[8:11], v[36:43], v53 abid:1
  ds_read_b128 v[36:39], v57 offset:8192
  ds_read_b128 v[40:43], v57 offset:9216
  s_waitcnt lgkmcnt(2)
  v_smfmac_f32_16x16x64_bf16 v[28:31], v[12:15], v[44:51], v53 abid:1
  ds_read_b128 v[44:47], v57 offset:10240
  ds_read_b128 v[48:51], v57 offset:11264
  v_smfmac_f32_16x16x64_bf16 v[28:31], v[16:19], a[64:71], v53 abid:1
  v_smfmac_f32_16x16x64_bf16 v[28:31], v[20:23], a[72:79], v53 abid:1
  v_add_f32 v58, v24, v26
  s_waitcnt lgkmcnt(2)
  v_smfmac_f32_16x16x64_bf16 v[32:35], v[8:11], v[36:43], v53 abid:1
  ds_read_b128 v[36:39], v57 offset:16384
  ds_read_b128 v[40:43], v57 offset:17408
  v_add_f32 v59, v25, v27
  s_waitcnt lgkmcnt(2)
  v_smfmac_f32_16x16x64_bf16 v[32:35], v[12:15], v[44:51], v53 abid:1
  ds_read_b128 v[44:47], v57 offset:18432
  ds_read_b128 v[48:51], v57 offset:19456
  v_mov_b64 v[24:25], 0
  v_mov_b64 v[26:27], 0
  v_smfmac_f32_16x16x64_bf16 v[32:35], v[16:19], a[96:103], v53 abid:1
  v_add_f32_dpp v60, v59, v58 quad_perm:[1,0,3,2] row_mask:0xf bank_mask:0xf
  v_smfmac_f32_16x16x64_bf16 v[32:35], v[20:23], a[104:111], v53 abid:1
  v_add_f32 v58, v28, v30
  s_waitcnt lgkmcnt(2)
  v_smfmac_f32_16x16x64_bf16 v[24:27], v[8:11], v[36:43], v53 abid:1
  ds_read_b128 v[36:39], v57 offset:24576
  ds_read_b128 v[40:43], v57 offset:25600
  v_add_f32 v59, v29, v31
  s_waitcnt lgkmcnt(2)
  v_smfmac_f32_16x16x64_bf16 v[24:27], v[12:15], v[44:51], v53 abid:1
  ds_read_b128 v[44:47], v57 offset:26624
  ds_read_b128 v[48:51], v57 offset:27648
  v_mov_b64 v[28:29], 0
  v_mov_b64 v[30:31], 0
  v_smfmac_f32_16x16x64_bf16 v[24:27], v[16:19], a[128:135], v53 abid:1
  v_add_f32_dpp v59, v58, v59 quad_perm:[1,0,3,2] row_mask:0xf bank_mask:0xf
  v_cndmask_b32 v60, v60, v59, s[96:97]
  v_smfmac_f32_16x16x64_bf16 v[24:27], v[20:23], a[136:143], v53 abid:1
  v_add_f32 v58, v32, v34
  s_waitcnt lgkmcnt(2)
  v_smfmac_f32_16x16x64_bf16 v[28:31], v[8:11], v[36:43], v53 abid:1
  v_add_f32 v59, v33, v35
  s_waitcnt lgkmcnt(0)
  v_smfmac_f32_16x16x64_bf16 v[28:31], v[12:15], v[44:51], v53 abid:1
  v_mov_b64 v[32:33], 0
  v_mov_b64 v[34:35], 0
  v_smfmac_f32_16x16x64_bf16 v[28:31], v[16:19], a[160:167], v53 abid:1
  v_add_f32_dpp v61, v59, v58 quad_perm:[1,0,3,2] row_mask:0xf bank_mask:0xf
  v_smfmac_f32_16x16x64_bf16 v[28:31], v[20:23], a[168:175], v53 abid:1
  v_add_f32 v58, v24, v26
L_qk_skip:
  ds_read_b128 v[36:39], v3 offset:4096
  ds_read_b128 v[40:43], v3 offset:5120
  ds_read_b128 v[44:47], v3 offset:6144
  ds_read_b128 v[48:51], v3 offset:7168
  v_smfmac_f32_16x16x64_bf16 v[32:35], v[8:11], a[192:199], v53 abid:1
  v_add_f32 v59, v25, v27
  v_smfmac_f32_16x16x64_bf16 v[32:35], v[12:15], a[200:207], v53 abid:1
  v_mov_b64 v[24:25], 0
  v_mov_b64 v[26:27], 0
  v_smfmac_f32_16x16x64_bf16 v[32:35], v[16:19], a[224:231], v53 abid:1
  v_add_f32_dpp v59, v58, v59 quad_perm:[1,0,3,2] row_mask:0xf bank_mask:0xf
  v_cndmask_b32 v61, v61, v59, s[96:97]
  v_smfmac_f32_16x16x64_bf16 v[32:35], v[20:23], a[232:239], v53 abid:1
  v_add_f32 v58, v28, v30
  s_waitcnt vmcnt(10)
  s_cmp_gt_i32 s92, 0
  s_cbranch_scc1 L_d_42
  s_waitcnt vmcnt(7)
L_d_42:
  buffer_load_dwordx4 v[84:87], v52, s[12:15], s29 offen offset:2048 nt
  v_smfmac_f32_16x16x64_bf16 v[24:27], v[8:11], v[64:71], v53 abid:1
  v_add_f32 v59, v29, v31
  v_smfmac_f32_16x16x64_bf16 v[24:27], v[12:15], v[72:79], v53 abid:1
  v_mov_b64 v[28:29], 0
  v_mov_b64 v[30:31], 0
  v_smfmac_f32_16x16x64_bf16 v[24:27], v[16:19], v[96:103], v53 abid:1
  v_add_f32_dpp v62, v59, v58 quad_perm:[1,0,3,2] row_mask:0xf bank_mask:0xf
  v_smfmac_f32_16x16x64_bf16 v[24:27], v[20:23], v[104:111], v53 abid:1
  v_add_f32 v58, v32, v34
  s_waitcnt vmcnt(10)
  s_cmp_gt_i32 s92, 0
  s_cbranch_scc1 L_d_43
  s_waitcnt vmcnt(6)
L_d_43:
  buffer_load_dwordx4 v[88:91], v52, s[12:15], s29 offen offset:128 nt
  v_smfmac_f32_16x16x64_bf16 v[28:31], v[8:11], v[128:135], v53 abid:1
  v_add_f32 v59, v33, v35
  v_smfmac_f32_16x16x64_bf16 v[28:31], v[12:15], v[136:143], v53 abid:1
  v_mov_b64 v[32:33], 0
  v_mov_b64 v[34:35], 0
  v_smfmac_f32_16x16x64_bf16 v[28:31], v[16:19], v[160:167], v53 abid:1
  v_add_f32_dpp v59, v58, v59 quad_perm:[1,0,3,2] row_mask:0xf bank_mask:0xf
  v_cndmask_b32 v62, v62, v59, s[96:97]
  v_smfmac_f32_16x16x64_bf16 v[28:31], v[20:23], v[168:175], v53 abid:1
  v_add_f32 v58, v24, v26
  s_waitcnt vmcnt(10)
  s_cmp_gt_i32 s92, 0
  s_cbranch_scc1 L_d_44
  s_waitcnt vmcnt(6)
L_d_44:
  buffer_load_dwordx4 v[92:95], v52, s[12:15], s29 offen offset:2176 nt
  v_smfmac_f32_16x16x64_bf16 v[32:35], v[8:11], v[192:199], v53 abid:1
  v_add_f32 v59, v25, v27
  v_smfmac_f32_16x16x64_bf16 v[32:35], v[12:15], v[200:207], v53 abid:1
  s_nop 0
  v_add_f32_dpp v63, v59, v58 quad_perm:[1,0,3,2] row_mask:0xf bank_mask:0xf
  v_smfmac_f32_16x16x64_bf16 v[32:35], v[16:19], v[224:231], v53 abid:1
  v_smfmac_f32_16x16x64_bf16 v[32:35], v[20:23], v[232:239], v53 abid:1
  v_add_f32 v58, v28, v30
  s_waitcnt lgkmcnt(0)
  s_bcnt1_i32_b64 s80, s[80:81]
  s_bcnt1_i32_b64 s81, s[82:83]
  s_bcnt1_i32_b64 s82, s[84:85]
  s_bcnt1_i32_b64 s83, s[86:87]
  s_add_u32 s80, s80, s81
  s_add_u32 s82, s82, s83
  s_add_u32 s80, s80, s82
  s_cmp_ge_u32 s80, s68
  s_cselect_b32 s80, 6, 0
  s_sub_u32 s92, s92, 1
  s_cselect_b32 s92, s80, s92
  s_buffer_load_dwordx8 s[80:87], s[16:19], s69 offset:2304
  s_mov_b64 exec, 0x110
  s_cmp_eq_u32 s3, 1
  s_cselect_b32 s50, 0x800000, 0
  buffer_store_byte v2, v2, s[48:51], s93 offen offset:2176
  s_mov_b64 exec, -1
  s_waitcnt vmcnt(11)
  s_cmp_gt_i32 s92, 0
  s_cbranch_scc1 L_d_45
  s_waitcnt vmcnt(7)
L_d_45:
  s_add_u32 s29, s27, s76
  s_add_u32 s29, s29, 0x34000
  buffer_load_dwordx4 v[112:115], v52, s[12:15], s29 offen offset:0 nt
  v_add_f32 v59, v29, v31
  s_nop 1
  v_add_f32_dpp v59, v58, v59 quad_perm:[1,0,3,2] row_mask:0xf bank_mask:0xf
  v_cndmask_b32 v63, v63, v59, s[96:97]
  v_mov_b64 v[22:23], 0
  v_mov_b64 v[20:21], 0
  v_mov_b64 v[18:19], 0
  v_mov_b64 v[16:17], 0
  v_add_f32 v58, v32, v34
  v_add_f32 v59, v33, v35
  v_mov_b64 v[14:15], 0
  v_mov_b64 v[12:13], 0
  v_add_f32_dpp v58, v59, v58 quad_perm:[1,0,3,2] row_mask:0xf bank_mask:0xf
  v_cndmask_b32 v5, v58, v5, s[96:97]
  s_cmp_eq_u32 s30, 2
  s_cbranch_scc0 L_nocopy
  v_mov_b32 v60, v6
  v_mov_b32 v61, v7
  v_cndmask_b32 v62, v56, v62, s[96:97]
  s_nop 1
L_nocopy:
  s_waitcnt vmcnt(10)
  s_cmp_gt_i32 s92, 0
  s_cbranch_scc1 L_d_46
  s_waitcnt vmcnt(7)
L_d_46:
  buffer_load_dwordx4 v[116:119], v52, s[12:15], s29 offen offset:2048 nt
  v_max3_f32 v24, v60, v61, v62
  v_max3_f32 v24, v24, v63, v5
  v_mov_b64 v[8:9], 0
  v_mov_b64 v[10:11], 0
  v_max_f32_dpp v24, v24, v24 row_ror:8 row_mask:0xf bank_mask:0xf
  v_lshrrev_b32 v27, 2, v2
  v_lshlrev_b32 v32, 22, v2
  v_max_f32_dpp v24, v24, v24 row_ror:4 row_mask:0xf bank_mask:0xf
  v_lshrrev_b32 v33, 5, v2
  v_and_b32 v32, 0x3c000000, v32
  v_max_f32_dpp v24, v24, v24 row_ror:2 row_mask:0xf bank_mask:0xf
  v_add3_u32 v32, v32, v33, s24
  s_nop 0
  v_max_f32_dpp v24, v24, v24 row_ror:1 row_mask:0xf bank_mask:0xf
  v_mov_b32 v26, v24
  s_nop 1
  v_permlane32_swap_b32 v24, v26
  v_max_f32 v24, v24, v26
  v_mov_b32 v26, v24
  s_nop 1
  v_permlane16_swap_b32 v24, v26
  v_max_f32 v24, v24, v26
  v_mul_f32 v24, s60, v24
  v_fma_f32 v60, v60, s60, -v24
  v_fma_f32 v61, v61, s60, -v24
  v_fma_f32 v62, v62, s60, -v24
  v_fma_f32 v63, v63, s60, -v24
  v_fma_f32 v5, v5, s60, -v24
  v_exp_f32 v60, v60
  v_exp_f32 v61, v61
  v_exp_f32 v62, v62
  v_exp_f32 v63, v63
  v_exp_f32 v5, v5
  v_add_f32 v25, v60, v61
  v_cvt_pk_bf16_f32 v60, v60, 0
  v_cvt_pk_bf16_f32 v61, v61, 0
  v_add_f32 v25, v25, v62
  v_cvt_pk_bf16_f32 v62, v62, 0
  v_add_f32 v25, v25, v63
  v_cvt_pk_bf16_f32 v63, v63, 0
  v_add_f32 v25, v25, v5
  v_cvt_pk_bf16_f32 v5, v5, 0
  v_mov_b32_dpp v8, v60 quad_perm:[0,0,0,0] row_mask:0xf bank_mask:0x3
  v_mov_b32_dpp v10, v60 quad_perm:[2,2,2,2] row_mask:0xf bank_mask:0x3
  s_nop 0
  v_mov_b32_dpp v9, v8 row_ror:8 row_mask:0xf bank_mask:0xc
  v_mov_b32_dpp v11, v10 row_ror:8 row_mask:0xf bank_mask:0xc
  v_mov_b32_dpp v12, v60 quad_perm:[1,1,1,1] row_mask:0xf bank_mask:0x3
  v_mov_b32_dpp v14, v60 quad_perm:[3,3,3,3] row_mask:0xf bank_mask:0x3
  v_add_f32_dpp v25, v25, v25 row_ror:8 row_mask:0xf bank_mask:0xf
  v_smfmac_f32_16x16x64_bf16 v[16:19], v[8:11], a[16:23], v53
  v_mov_b32_dpp v13, v12 row_ror:8 row_mask:0xf bank_mask:0xc
  v_mov_b32_dpp v15, v14 row_ror:8 row_mask:0xf bank_mask:0xc
  v_add_f32_dpp v25, v25, v25 row_ror:4 row_mask:0xf bank_mask:0xf
  v_smfmac_f32_16x16x64_bf16 v[20:23], v[8:11], a[24:31], v53
  v_mov_b32_dpp v9, v60 quad_perm:[0,0,0,0] row_mask:0xf bank_mask:0xc
  v_mov_b32_dpp v11, v60 quad_perm:[2,2,2,2] row_mask:0xf bank_mask:0xc
  v_add_f32_dpp v25, v25, v25 row_ror:2 row_mask:0xf bank_mask:0xf
  v_smfmac_f32_16x16x64_bf16 v[16:19], v[12:15], v[36:43], v53
  ds_read_b128 v[36:39], v3 offset:12288
  ds_read_b128 v[40:43], v3 offset:13312
  v_mov_b32_dpp v8, v9 row_ror:8 row_mask:0xf bank_mask:0x3
  v_mov_b32_dpp v10, v11 row_ror:8 row_mask:0xf bank_mask:0x3
  v_add_f32_dpp v25, v25, v25 row_ror:1 row_mask:0xf bank_mask:0xf
  s_waitcnt vmcnt(10)
  s_cmp_gt_i32 s92, 0
  s_cbranch_scc1 L_d_47
  s_waitcnt vmcnt(6)
L_d_47:
  buffer_load_dwordx4 v[120:123], v52, s[12:15], s29 offen offset:128 nt
  v_smfmac_f32_16x16x64_bf16 v[20:23], v[12:15], v[44:51], v53
  ds_read_b128 v[44:47], v3 offset:14336
  ds_read_b128 v[48:51], v3 offset:15360
  v_mov_b32_dpp v13, v60 quad_perm:[1,1,1,1] row_mask:0xf bank_mask:0xc
  v_mov_b32_dpp v15, v60 quad_perm:[3,3,3,3] row_mask:0xf bank_mask:0xc
  buffer_store_dwordx2 v[24:25], v32, s[40:43], s32 offen
  buffer_store_dwordx2 v[24:25], v32, s[44:47], s32 offen sc1
  v_smfmac_f32_16x16x64_bf16 v[16:19], v[8:11], a[48:55], v53
  v_mov_b32_dpp v12, v13 row_ror:8 row_mask:0xf bank_mask:0x3
  v_mov_b32_dpp v14, v15 row_ror:8 row_mask:0xf bank_mask:0x3
  v_smfmac_f32_16x16x64_bf16 v[20:23], v[8:11], a[56:63], v53
  v_mov_b32_dpp v8, v61 quad_perm:[0,0,0,0] row_mask:0xf bank_mask:0x3
  v_mov_b32_dpp v10, v61 quad_perm:[2,2,2,2] row_mask:0xf bank_mask:0x3
  v_smfmac_f32_16x16x64_bf16 v[16:19], v[12:15], a[80:87], v53
  v_mov_b32_dpp v9, v8 row_ror:8 row_mask:0xf bank_mask:0xc
  v_mov_b32_dpp v11, v10 row_ror:8 row_mask:0xf bank_mask:0xc
  s_waitcnt vmcnt(12)
  s_cmp_gt_i32 s92, 0
  s_cbranch_scc1 L_d_48
  s_waitcnt vmcnt(8)
L_d_48:
  buffer_load_dwordx4 v[124:127], v52, s[12:15], s29 offen offset:2176 nt
  v_smfmac_f32_16x16x64_bf16 v[20:23], v[12:15], a[88:95], v53
  v_mov_b32_dpp v13, v61 quad_perm:[0,0,0,0] row_mask:0xf bank_mask:0xc
  v_mov_b32_dpp v15, v61 quad_perm:[2,2,2,2] row_mask:0xf bank_mask:0xc
  s_waitcnt lgkmcnt(2)
  v_smfmac_f32_16x16x64_bf16 v[16:19], v[8:11], v[36:43], v53
  ds_read_b128 v[36:39], v3 offset:20480
  ds_read_b128 v[40:43], v3 offset:21504
  v_mov_b32_dpp v12, v13 row_ror:8 row_mask:0xf bank_mask:0x3
  v_mov_b32_dpp v14, v15 row_ror:8 row_mask:0xf bank_mask:0x3
  s_waitcnt lgkmcnt(2)
  v_smfmac_f32_16x16x64_bf16 v[20:23], v[8:11], v[44:51], v53
  ds_read_b128 v[44:47], v3 offset:22528
  ds_read_b128 v[48:51], v3 offset:23552
  v_mov_b32_dpp v8, v61 quad_perm:[1,1,1,1] row_mask:0xf bank_mask:0x3
  v_mov_b32_dpp v10, v61 quad_perm:[3,3,3,3] row_mask:0xf bank_mask:0x3
  v_smfmac_f32_16x16x64_bf16 v[16:19], v[12:15], a[112:119], v53
  v_mov_b32_dpp v9, v8 row_ror:8 row_mask:0xf bank_mask:0xc
  v_mov_b32_dpp v11, v10 row_ror:8 row_mask:0xf bank_mask:0xc
  s_waitcnt lgkmcnt(0)
  s_bcnt1_i32_b64 s80, s[80:81]
  s_bcnt1_i32_b64 s81, s[82:83]
  s_bcnt1_i32_b64 s82, s[84:85]
  s_bcnt1_i32_b64 s83, s[86:87]
  s_add_u32 s80, s80, s81
  s_add_u32 s82, s82, s83
  s_add_u32 s80, s80, s82
  s_cmp_ge_u32 s80, s68
  s_cselect_b32 s80, 6, 0
  s_sub_u32 s92, s92, 1
  s_cselect_b32 s92, s80, s92
  s_buffer_load_dwordx8 s[80:87], s[16:19], s69 offset:2432
  s_mov_b64 exec, 0x110
  s_cmp_eq_u32 s3, 2
  s_cselect_b32 s50, 0x800000, 0
  buffer_store_byte v2, v2, s[48:51], s93 offen offset:2304
  s_mov_b64 exec, -1
  s_waitcnt vmcnt(13)
  s_cmp_gt_i32 s92, 0
  s_cbranch_scc1 L_d_49
  s_waitcnt vmcnt(9)
L_d_49:
  s_add_u32 s29, s27, s77
  s_add_u32 s29, s29, 0x38000
  buffer_load_dwordx4 v[144:147], v52, s[12:15], s29 offen offset:0 nt
  v_smfmac_f32_16x16x64_bf16 v[20:23], v[12:15], a[120:127], v53
  v_mov_b32_dpp v13, v61 quad_perm:[1,1,1,1] row_mask:0xf bank_mask:0xc
  v_mov_b32_dpp v15, v61 quad_perm:[3,3,3,3] row_mask:0xf bank_mask:0xc
  v_smfmac_f32_16x16x64_bf16 v[16:19], v[8:11], v[36:43], v53
  ds_read_b128 v[36:39], v3 offset:28672
  ds_read_b128 v[40:43], v3 offset:29696
  v_mov_b32_dpp v12, v13 row_ror:8 row_mask:0xf bank_mask:0x3
  v_mov_b32_dpp v14, v15 row_ror:8 row_mask:0xf bank_mask:0x3
  v_smfmac_f32_16x16x64_bf16 v[20:23], v[8:11], v[44:51], v53
  ds_read_b128 v[44:47], v3 offset:30720
  ds_read_b128 v[48:51], v3 offset:31744
  v_mov_b32_dpp v8, v62 quad_perm:[0,0,0,0] row_mask:0xf bank_mask:0x3
  v_mov_b32_dpp v10, v62 quad_perm:[2,2,2,2] row_mask:0xf bank_mask:0x3
  v_smfmac_f32_16x16x64_bf16 v[16:19], v[12:15], a[144:151], v53
  v_mov_b32_dpp v9, v8 row_ror:8 row_mask:0xf bank_mask:0xc
  v_mov_b32_dpp v11, v10 row_ror:8 row_mask:0xf bank_mask:0xc
  s_waitcnt vmcnt(12)
  s_cmp_gt_i32 s92, 0
  s_cbranch_scc1 L_d_50
  s_waitcnt vmcnt(9)
L_d_50:
  buffer_load_dwordx4 v[148:151], v52, s[12:15], s29 offen offset:2048 nt
  v_smfmac_f32_16x16x64_bf16 v[20:23], v[12:15], a[152:159], v53
  v_mov_b32_dpp v13, v62 quad_perm:[0,0,0,0] row_mask:0xf bank_mask:0xc
  v_mov_b32_dpp v15, v62 quad_perm:[2,2,2,2] row_mask:0xf bank_mask:0xc
  s_waitcnt lgkmcnt(2)
  v_smfmac_f32_16x16x64_bf16 v[16:19], v[8:11], v[36:43], v53
  v_mov_b32_dpp v12, v13 row_ror:8 row_mask:0xf bank_mask:0x3
  v_mov_b32_dpp v14, v15 row_ror:8 row_mask:0xf bank_mask:0x3
  s_waitcnt lgkmcnt(0)
  v_smfmac_f32_16x16x64_bf16 v[20:23], v[8:11], v[44:51], v53
  v_mov_b32_dpp v8, v62 quad_perm:[1,1,1,1] row_mask:0xf bank_mask:0x3
  v_mov_b32_dpp v10, v62 quad_perm:[3,3,3,3] row_mask:0xf bank_mask:0x3
  v_smfmac_f32_16x16x64_bf16 v[16:19], v[12:15], a[176:183], v53
  v_mov_b32_dpp v9, v8 row_ror:8 row_mask:0xf bank_mask:0xc
  v_mov_b32_dpp v11, v10 row_ror:8 row_mask:0xf bank_mask:0xc
  s_waitcnt vmcnt(12)
  s_cmp_gt_i32 s92, 0
  s_cbranch_scc1 L_d_51
  s_waitcnt vmcnt(8)
L_d_51:
  buffer_load_dwordx4 v[152:155], v52, s[12:15], s29 offen offset:128 nt
  v_smfmac_f32_16x16x64_bf16 v[20:23], v[12:15], a[184:191], v53
  v_mov_b32_dpp v13, v62 quad_perm:[1,1,1,1] row_mask:0xf bank_mask:0xc
  v_mov_b32_dpp v15, v62 quad_perm:[3,3,3,3] row_mask:0xf bank_mask:0xc
  v_smfmac_f32_16x16x64_bf16 v[16:19], v[8:11], a[208:215], v53
  v_mov_b32_dpp v12, v13 row_ror:8 row_mask:0xf bank_mask:0x3
  v_mov_b32_dpp v14, v15 row_ror:8 row_mask:0xf bank_mask:0x3
  v_smfmac_f32_16x16x64_bf16 v[20:23], v[8:11], a[216:223], v53
  v_mov_b32_dpp v8, v63 quad_perm:[0,0,0,0] row_mask:0xf bank_mask:0x3
  v_mov_b32_dpp v10, v63 quad_perm:[2,2,2,2] row_mask:0xf bank_mask:0x3
  v_smfmac_f32_16x16x64_bf16 v[16:19], v[12:15], a[240:247], v53
  v_mov_b32_dpp v9, v8 row_ror:8 row_mask:0xf bank_mask:0xc
  v_mov_b32_dpp v11, v10 row_ror:8 row_mask:0xf bank_mask:0xc
  s_waitcnt vmcnt(12)
  s_cmp_gt_i32 s92, 0
  s_cbranch_scc1 L_d_52
  s_waitcnt vmcnt(8)
L_d_52:
  buffer_load_dwordx4 v[156:159], v52, s[12:15], s29 offen offset:2176 nt
  v_smfmac_f32_16x16x64_bf16 v[20:23], v[12:15], a[248:255], v53
  v_mov_b32_dpp v13, v63 quad_perm:[0,0,0,0] row_mask:0xf bank_mask:0xc
  v_mov_b32_dpp v15, v63 quad_perm:[2,2,2,2] row_mask:0xf bank_mask:0xc
  v_smfmac_f32_16x16x64_bf16 v[16:19], v[8:11], v[80:87], v53
  v_mov_b32_dpp v12, v13 row_ror:8 row_mask:0xf bank_mask:0x3
  v_mov_b32_dpp v14, v15 row_ror:8 row_mask:0xf bank_mask:0x3
  s_waitcnt vmcnt(12)
  v_smfmac_f32_16x16x64_bf16 v[20:23], v[8:11], v[88:95], v53
  v_mov_b32_dpp v8, v63 quad_perm:[1,1,1,1] row_mask:0xf bank_mask:0x3
  v_mov_b32_dpp v10, v63 quad_perm:[3,3,3,3] row_mask:0xf bank_mask:0x3
  s_waitcnt lgkmcnt(0)
  s_bcnt1_i32_b64 s80, s[80:81]
  s_bcnt1_i32_b64 s81, s[82:83]
  s_bcnt1_i32_b64 s82, s[84:85]
  s_bcnt1_i32_b64 s83, s[86:87]
  s_add_u32 s80, s80, s81
  s_add_u32 s82, s82, s83
  s_add_u32 s80, s80, s82
  s_cmp_ge_u32 s80, s68
  s_cselect_b32 s80, 6, 0
  s_sub_u32 s92, s92, 1
  s_cselect_b32 s92, s80, s92
  s_buffer_load_dwordx8 s[80:87], s[16:19], s69 offset:2560
  s_mov_b64 exec, 0x110
  s_cmp_eq_u32 s3, 3
  s_cselect_b32 s50, 0x800000, 0
  buffer_store_byte v2, v2, s[48:51], s93 offen offset:2432
  s_mov_b64 exec, -1
  s_cmp_gt_i32 s92, 0
  s_cbranch_scc1 L_d_53
  s_waitcnt vmcnt(9)
L_d_53:
  s_add_u32 s29, s27, s77
  s_add_u32 s29, s29, 0x3c000
  buffer_load_dwordx4 v[176:179], v52, s[12:15], s29 offen offset:0 nt
  s_waitcnt vmcnt(12)
  s_cmp_gt_i32 s92, 0
  s_cbranch_scc1 L_d_54
  s_waitcnt vmcnt(7)
L_d_54:
  buffer_load_dwordx4 v[180:183], v52, s[12:15], s29 offen offset:2048 nt
  s_waitcnt vmcnt(12)
  v_smfmac_f32_16x16x64_bf16 v[16:19], v[12:15], v[112:119], v53
  v_mov_b32_dpp v9, v8 row_ror:8 row_mask:0xf bank_mask:0xc
  v_mov_b32_dpp v11, v10 row_ror:8 row_mask:0xf bank_mask:0xc
  s_cmp_gt_i32 s92, 0
  s_cbranch_scc1 L_d_55
  s_waitcnt vmcnt(6)
L_d_55:
  buffer_load_dwordx4 v[184:187], v52, s[12:15], s29 offen offset:128 nt
  s_waitcnt vmcnt(12)
  s_cmp_gt_i32 s92, 0
  s_cbranch_scc1 L_d_56
  s_waitcnt vmcnt(6)
L_d_56:
  buffer_load_dwordx4 v[188:191], v52, s[12:15], s29 offen offset:2176 nt
  s_waitcnt vmcnt(10)
  v_smfmac_f32_16x16x64_bf16 v[20:23], v[12:15], v[120:127], v53
  v_mov_b32_dpp v13, v63 quad_perm:[1,1,1,1] row_mask:0xf bank_mask:0xc
  v_mov_b32_dpp v15, v63 quad_perm:[3,3,3,3] row_mask:0xf bank_mask:0xc
  s_waitcnt lgkmcnt(0)
  s_bcnt1_i32_b64 s80, s[80:81]
  s_bcnt1_i32_b64 s81, s[82:83]
  s_bcnt1_i32_b64 s82, s[84:85]
  s_bcnt1_i32_b64 s83, s[86:87]
  s_add_u32 s80, s80, s81
  s_add_u32 s82, s82, s83
  s_add_u32 s80, s80, s82
  s_cmp_ge_u32 s80, s68
  s_cselect_b32 s80, 6, 0
  s_sub_u32 s92, s92, 1
  s_cselect_b32 s92, s80, s92
  s_buffer_load_dwordx8 s[80:87], s[16:19], s69 offset:2688
  s_mov_b64 exec, 0x110
  s_cmp_eq_u32 s3, 0
  s_cselect_b32 s50, 0x800000, 0
  buffer_store_byte v2, v2, s[48:51], s93 offen offset:2560
  s_mov_b64 exec, -1
  s_cmp_gt_i32 s92, 0
  s_cbranch_scc1 L_d_57
  s_waitcnt vmcnt(7)
L_d_57:
  s_add_u32 s29, s27, s78
  s_add_u32 s29, s29, 0x40000
  buffer_load_dwordx4 v[208:211], v52, s[12:15], s29 offen offset:0 nt
  s_waitcnt vmcnt(10)
  s_cmp_gt_i32 s92, 0
  s_cbranch_scc1 L_d_58
  s_waitcnt vmcnt(7)
L_d_58:
  buffer_load_dwordx4 v[212:215], v52, s[12:15], s29 offen offset:2048 nt
  s_waitcnt vmcnt(10)
  v_smfmac_f32_16x16x64_bf16 v[16:19], v[8:11], v[144:151], v53
  v_mov_b32_dpp v12, v13 row_ror:8 row_mask:0xf bank_mask:0x3
  v_mov_b32_dpp v14, v15 row_ror:8 row_mask:0xf bank_mask:0x3
  s_cmp_gt_i32 s92, 0
  s_cbranch_scc1 L_d_59
  s_waitcnt vmcnt(9)
L_d_59:
  buffer_load_dwordx4 v[216:219], v52, s[12:15], s29 offen offset:128 nt
  s_waitcnt vmcnt(10)
  s_cmp_gt_i32 s92, 0
  s_cbranch_scc1 L_d_60
  s_waitcnt vmcnt(9)
L_d_60:
  buffer_load_dwordx4 v[220:223], v52, s[12:15], s29 offen offset:2176 nt
  s_waitcnt vmcnt(10)
  v_smfmac_f32_16x16x64_bf16 v[20:23], v[8:11], v[152:159], v53
  v_mov_b32_dpp v8, v5 quad_perm:[0,0,0,0] row_mask:0xf bank_mask:0x3
  v_mov_b32_dpp v10, v5 quad_perm:[2,2,2,2] row_mask:0xf bank_mask:0x3
  s_waitcnt lgkmcnt(0)
  s_bcnt1_i32_b64 s80, s[80:81]
  s_bcnt1_i32_b64 s81, s[82:83]
  s_bcnt1_i32_b64 s82, s[84:85]
  s_bcnt1_i32_b64 s83, s[86:87]
  s_add_u32 s80, s80, s81
  s_add_u32 s82, s82, s83
  s_add_u32 s80, s80, s82
  s_cmp_ge_u32 s80, s68
  s_cselect_b32 s80, 6, 0
  s_sub_u32 s92, s92, 1
  s_cselect_b32 s92, s80, s92
  s_buffer_load_dwordx8 s[80:87], s[16:19], s69 offset:2816
  s_mov_b64 exec, 0x110
  s_cmp_eq_u32 s3, 1
  s_cselect_b32 s50, 0x800000, 0
  buffer_store_byte v2, v2, s[48:51], s93 offen offset:2688
  s_mov_b64 exec, -1
  s_cmp_gt_i32 s92, 0
  s_cbranch_scc1 L_d_61
  s_waitcnt vmcnt(9)
L_d_61:
  s_add_u32 s29, s27, s78
  s_add_u32 s29, s29, 0x44000
  buffer_load_dwordx4 v[240:243], v52, s[12:15], s29 offen offset:0 nt
  s_waitcnt vmcnt(10)
  s_cmp_gt_i32 s92, 0
  s_cbranch_scc1 L_d_62
  s_waitcnt vmcnt(9)
L_d_62:
  buffer_load_dwordx4 v[244:247], v52, s[12:15], s29 offen offset:2048 nt
  s_waitcnt vmcnt(10)
  v_smfmac_f32_16x16x64_bf16 v[16:19], v[12:15], v[176:183], v53
  v_mov_b32_dpp v9, v8 row_ror:8 row_mask:0xf bank_mask:0xc
  v_mov_b32_dpp v11, v10 row_ror:8 row_mask:0xf bank_mask:0xc
  s_cmp_gt_i32 s92, 0
  s_cbranch_scc1 L_d_63
  s_waitcnt vmcnt(9)
L_d_63:
  buffer_load_dwordx4 v[248:251], v52, s[12:15], s29 offen offset:128 nt
  s_waitcnt vmcnt(10)
  s_cmp_gt_i32 s92, 0
  s_cbranch_scc1 L_d_64
  s_waitcnt vmcnt(9)
L_d_64:
  buffer_load_dwordx4 v[252:255], v52, s[12:15], s29 offen offset:2176 nt
  s_waitcnt vmcnt(10)
  v_smfmac_f32_16x16x64_bf16 v[20:23], v[12:15], v[184:191], v53
  v_mov_b32_dpp v13, v5 quad_perm:[0,0,0,0] row_mask:0xf bank_mask:0xc
  v_mov_b32_dpp v15, v5 quad_perm:[2,2,2,2] row_mask:0xf bank_mask:0xc
  s_waitcnt vmcnt(8)
  s_waitcnt vmcnt(7)
  v_smfmac_f32_16x16x64_bf16 v[16:19], v[8:11], v[208:215], v53
  v_mov_b32_dpp v12, v13 row_ror:8 row_mask:0xf bank_mask:0x3
  v_mov_b32_dpp v14, v15 row_ror:8 row_mask:0xf bank_mask:0x3
  s_waitcnt vmcnt(6)
  buffer_load_dwordx4 v[28:31], v4, s[16:19], s26 offen sc1
  s_waitcnt lgkmcnt(0)
  s_bcnt1_i32_b64 s80, s[80:81]
  s_bcnt1_i32_b64 s81, s[82:83]
  s_bcnt1_i32_b64 s82, s[84:85]
  s_bcnt1_i32_b64 s83, s[86:87]
  s_add_u32 s80, s80, s81
  s_add_u32 s82, s82, s83
  s_add_u32 s80, s80, s82
  s_cmp_ge_u32 s80, s68
  s_cselect_b32 s80, 6, 0
  s_sub_u32 s92, s92, 1
  s_cselect_b32 s92, s80, s92
  s_mov_b64 exec, 0x110
  s_cmp_eq_u32 s3, 2
  s_cselect_b32 s50, 0x800000, 0
  buffer_store_byte v2, v2, s[48:51], s93 offen offset:2816
  s_mov_b64 exec, -1
  s_add_u32 s29, s28, 0x4000000
  s_add_u32 m0, s34, 32768
  s_nop 0
  buffer_load_dwordx4 v55, s[8:11], s29 offen offset:0 nt lds
  s_waitcnt vmcnt(8)
  v_smfmac_f32_16x16x64_bf16 v[20:23], v[8:11], v[216:223], v53
  s_add_u32 m0, s34, 33664
  s_nop 0
  buffer_load_dwordx4 v55, s[8:11], s29 offen offset:128 nt lds
  s_waitcnt vmcnt(7)
  s_waitcnt vmcnt(6)
  v_smfmac_f32_16x16x64_bf16 v[16:19], v[12:15], v[240:247], v53
  s_waitcnt vmcnt(5)
  s_waitcnt vmcnt(4)
  v_smfmac_f32_16x16x64_bf16 v[20:23], v[12:15], v[248:255], v53
  s_nop 7
  v_permlane16_swap_b32 v16, v20
  v_permlane16_swap_b32 v18, v22
  v_permlane16_swap_b32 v17, v21
  v_add_f32_dpp v16, v20, v16 row_ror:8 row_mask:0xf bank_mask:0x3
  v_add_f32_dpp v18, v22, v18 row_ror:8 row_mask:0xf bank_mask:0x3
  v_permlane16_swap_b32 v19, v23
  v_add_f32_dpp v16, v17, v21 row_ror:8 row_mask:0xf bank_mask:0xc
  s_nop 0
  v_add_f32_dpp v18, v19, v23 row_ror:8 row_mask:0xf bank_mask:0xc
  v_cvt_pk_bf16_f32 v16, v16, v18
  buffer_store_dword v16, v27, s[40:43], s32 offen
  buffer_store_dword v16, v27, s[44:47], s32 offen sc1
  s_add_u32 s32, s32, 0x80000
  s_barrier
L_rb:
  s_add_u32 m0, s34, 33792
  s_nop 0
  buffer_load_dwordx4 v55, s[8:11], s29 offen offset:1024 nt lds
  s_add_u32 m0, s34, 34688
  s_nop 0
  buffer_load_dwordx4 v55, s[8:11], s29 offen offset:1152 nt lds
  s_mov_b64 exec, 0x110
  s_cmp_eq_u32 s3, 3
  s_cselect_b32 s50, 0x800000, 0
  buffer_store_byte v2, v2, s[48:51], s93 offen offset:2944
  s_mov_b64 exec, -1
  s_add_u32 s29, s28, 0x4000800
  s_add_u32 m0, s34, 36864
  s_nop 0
  buffer_load_dwordx4 v55, s[8:11], s29 offen offset:0 nt lds
  s_add_u32 m0, s34, 37760
  s_nop 0
  buffer_load_dwordx4 v55, s[8:11], s29 offen offset:128 nt lds
  s_add_u32 m0, s34, 37888
  s_nop 0
  buffer_load_dwordx4 v55, s[8:11], s29 offen offset:1024 nt lds
  s_add_u32 m0, s34, 38784
  s_nop 0
  buffer_load_dwordx4 v55, s[8:11], s29 offen offset:1152 nt lds
  s_cmp_eq_u32 s30, 0
  s_cbranch_scc1 L_after0
  s_mov_b64 exec, 0x110
  s_cmp_eq_u32 s3, 0
  s_cselect_b32 s50, 0x800000, 0
  buffer_store_byte v2, v2, s[48:51], s93 offen offset:3072
  s_mov_b64 exec, -1
  s_waitcnt vmcnt(7)
  s_add_u32 s29, s71, 0x4008800
  buffer_load_dwordx4 a[64:67], v1, s[8:11], s29 offen offset:0 nt
  s_waitcnt vmcnt(7)
  buffer_load_dwordx4 a[68:71], v1, s[8:11], s29 offen offset:128 nt
  s_waitcnt vmcnt(6)
  buffer_load_dwordx4 a[72:75], v1, s[8:11], s29 offen offset:1024 nt
  s_waitcnt vmcnt(6)
  buffer_load_dwordx4 a[76:79], v1, s[8:11], s29 offen offset:1152 nt
  s_mov_b64 exec, 0x110
  s_cmp_eq_u32 s3, 1
  s_cselect_b32 s50, 0x800000, 0
  buffer_store_byte v2, v2, s[48:51], s93 offen offset:3200
  s_mov_b64 exec, -1
  s_waitcnt vmcnt(7)
  s_add_u32 s29, s72, 0x4010000
  s_add_u32 m0, s34, 8192
  s_nop 0
  buffer_load_dwordx4 v55, s[8:11], s29 offen offset:0 nt lds
  s_waitcnt vmcnt(7)
  s_add_u32 m0, s34, 9088
  s_nop 0
  buffer_load_dwordx4 v55, s[8:11], s29 offen offset:128 nt lds
  s_waitcnt vmcnt(6)
  s_add_u32 m0, s34, 9216
  s_nop 0
  buffer_load_dwordx4 v55, s[8:11], s29 offen offset:1024 nt lds
  s_waitcnt vmcnt(6)
  s_add_u32 m0, s34, 10112
  s_nop 0
  buffer_load_dwordx4 v55, s[8:11], s29 offen offset:1152 nt lds
  s_waitcnt vmcnt(6)
  s_add_u32 s29, s72, 0x4010800
  buffer_load_dwordx4 a[96:99], v1, s[8:11], s29 offen offset:0 nt
  s_waitcnt vmcnt(6)
  buffer_load_dwordx4 a[100:103], v1, s[8:11], s29 offen offset:128 nt
  s_waitcnt vmcnt(5)
  buffer_load_dwordx4 a[104:107], v1, s[8:11], s29 offen offset:1024 nt
  s_waitcnt vmcnt(5)
  buffer_load_dwordx4 a[108:111], v1, s[8:11], s29 offen offset:1152 nt
  s_waitcnt vmcnt(5)
  s_add_u32 s29, s73, 0x4018000
  s_add_u32 m0, s34, 16384
  s_nop 0
  buffer_load_dwordx4 v55, s[8:11], s29 offen offset:0 nt lds
  s_waitcnt vmcnt(5)
  s_add_u32 m0, s34, 17280
  s_nop 0
  buffer_load_dwordx4 v55, s[8:11], s29 offen offset:128 nt lds
  s_waitcnt vmcnt(5)
  s_add_u32 m0, s34, 17408
  s_nop 0
  buffer_load_dwordx4 v55, s[8:11], s29 offen offset:1024 nt lds
  s_waitcnt vmcnt(5)
  s_add_u32 m0, s34, 18304
  s_nop 0
  buffer_load_dwordx4 v55, s[8:11], s29 offen offset:1152 nt lds
  s_waitcnt vmcnt(5)
  s_add_u32 s29, s73, 0x4018800
  buffer_load_dwordx4 a[128:131], v1, s[8:11], s29 offen offset:0 nt
  s_waitcnt vmcnt(5)
  buffer_load_dwordx4 a[132:135], v1, s[8:11], s29 offen offset:128 nt
  s_waitcnt vmcnt(5)
  buffer_load_dwordx4 a[136:139], v1, s[8:11], s29 offen offset:1024 nt
  s_waitcnt vmcnt(5)
  buffer_load_dwordx4 a[140:143], v1, s[8:11], s29 offen offset:1152 nt
  s_waitcnt vmcnt(5)
  s_add_u32 s29, s74, 0x4020000
  s_add_u32 m0, s34, 24576
  s_nop 0
  buffer_load_dwordx4 v55, s[8:11], s29 offen offset:0 nt lds
  s_waitcnt vmcnt(5)
  s_add_u32 m0, s34, 25472
  s_nop 0
  buffer_load_dwordx4 v55, s[8:11], s29 offen offset:128 nt lds
  s_waitcnt vmcnt(5)
  s_add_u32 m0, s34, 25600
  s_nop 0
  buffer_load_dwordx4 v55, s[8:11], s29 offen offset:1024 nt lds
  s_waitcnt vmcnt(5)
  s_add_u32 m0, s34, 26496
  s_nop 0
  buffer_load_dwordx4 v55, s[8:11], s29 offen offset:1152 nt lds
  s_waitcnt vmcnt(5)
  s_add_u32 s29, s74, 0x4020800
  buffer_load_dwordx4 a[160:163], v1, s[8:11], s29 offen offset:0 nt
  s_waitcnt vmcnt(5)
  buffer_load_dwordx4 a[164:167], v1, s[8:11], s29 offen offset:128 nt
  s_waitcnt vmcnt(5)
  buffer_load_dwordx4 a[168:171], v1, s[8:11], s29 offen offset:1024 nt
  s_waitcnt vmcnt(5)
  buffer_load_dwordx4 a[172:175], v1, s[8:11], s29 offen offset:1152 nt
  s_add_u32 s29, s71, 0x4008000
  s_add_u32 m0, s34, 0
  s_nop 0
  buffer_load_dwordx4 v55, s[8:11], s29 offen offset:0 nt lds
  s_add_u32 m0, s34, 896
  s_nop 0
  buffer_load_dwordx4 v55, s[8:11], s29 offen offset:128 nt lds
  s_waitcnt vmcnt(7)
  s_add_u32 m0, s34, 1024
  s_nop 0
  buffer_load_dwordx4 v55, s[8:11], s29 offen offset:1024 nt lds
  s_waitcnt vmcnt(7)
  s_add_u32 m0, s34, 1920
  s_nop 0
  buffer_load_dwordx4 v55, s[8:11], s29 offen offset:1152 nt lds
  ds_read_b128 a[0:3], v57 offset:32768
  ds_read_b128 a[4:7], v57 offset:33792
  ds_read_b128 a[8:11], v57 offset:34816
  ds_read_b128 a[12:15], v57 offset:35840
  ds_read_b128 a[32:35], v57 offset:36864
  ds_read_b128 a[36:39], v57 offset:37888
  ds_read_b128 a[40:43], v57 offset:38912
  ds_read_b128 a[44:47], v57 offset:39936
  s_waitcnt vmcnt(0)
  ds_read_b128 v[36:39], v57 offset:0
  ds_read_b128 v[40:43], v57 offset:1024
  ds_read_b128 v[44:47], v57 offset:2048
  ds_read_b128 v[48:51], v57 offset:3072
  v_mov_b64 v[24:25], 0
  v_mov_b64 v[26:27], 0
  v_mov_b64 v[28:29], 0
  v_mov_b64 v[30:31], 0
  s_waitcnt lgkmcnt(0)
  s_mov_b32 s30, 3
  s_add_u32 s36, s33, 24576
  s_mov_b32 s61, 0
  buffer_load_dwordx4 v[32:35], v4, s[16:19], s36 offen sc1
  s_sleep 2
L_pqb:
  buffer_load_dwordx4 v[32:35], v4, s[16:19], s36 offen sc1
  s_waitcnt vmcnt(1)
  v_max3_u32 v58, v32, v33, v34
  v_max_u32 v58, v58, v35
  v_cmp_eq_u32 vcc, -1, v58
  v_cndmask_b32 v8, 0, v32, s[52:53]
  v_cndmask_b32 v9, 0, v33, s[52:53]
  v_cndmask_b32 v10, 0, v34, s[52:53]
  v_cndmask_b32 v11, 0, v35, s[52:53]
  v_cndmask_b32 v12, 0, v32, s[54:55]
  v_cndmask_b32 v13, 0, v33, s[54:55]
  s_cbranch_vccz L_C2b
  s_add_u32 s61, s61, 1
  s_cmp_gt_u32 s61, 20000
  s_cbranch_scc1 L_C2
  s_branch L_pqb
L_after0:
  s_waitcnt vmcnt(12)
  v_cndmask_b32 v8, 0, v28, s[52:53]
  v_cndmask_b32 v9, 0, v29, s[52:53]
  v_cndmask_b32 v10, 0, v30, s[52:53]
  v_cndmask_b32 v11, 0, v31, s[52:53]
  v_cndmask_b32 v12, 0, v28, s[54:55]
  v_cndmask_b32 v13, 0, v29, s[54:55]
  v_cndmask_b32 v14, 0, v30, s[54:55]
  v_cndmask_b32 v15, 0, v31, s[54:55]
  v_cndmask_b32 v16, 0, v28, s[56:57]
  v_cndmask_b32 v17, 0, v29, s[56:57]
  v_cndmask_b32 v18, 0, v30, s[56:57]
  v_cndmask_b32 v19, 0, v31, s[56:57]
  v_cndmask_b32 v20, 0, v28, s[58:59]
  v_cndmask_b32 v21, 0, v29, s[58:59]
  v_cndmask_b32 v22, 0, v30, s[58:59]
  v_cndmask_b32 v23, 0, v31, s[58:59]
  s_mov_b32 s92, 0
  s_add_u32 s36, s33, 8192
  v_mov_b64 v[24:25], 0
  v_mov_b64 v[26:27], 0
  s_waitcnt vmcnt(5)
  ds_read_b128 v[36:39], v57 offset:32768
  ds_read_b128 v[40:43], v57 offset:33792
  ds_read_b128 v[44:47], v57 offset:34816
  ds_read_b128 v[48:51], v57 offset:35840
  s_waitcnt lgkmcnt(0)
  s_mov_b64 exec, 0x110
  s_cmp_eq_u32 s3, 0
  s_cselect_b32 s50, 0x800000, 0
  buffer_store_byte v2, v2, s[48:51], s93 offen offset:3072
  s_mov_b64 exec, -1
  v_smfmac_f32_16x16x64_bf16 v[24:27], v[8:11], v[36:43], v53 abid:1
  v_smfmac_f32_16x16x64_bf16 v[24:27], v[12:15], v[44:51], v53 abid:1
  s_add_u32 s29, s71, 0x4008000
  s_add_u32 m0, s34, 32768
  s_nop 0
  buffer_load_dwordx4 v55, s[8:11], s29 offen offset:0 nt lds
  s_add_u32 m0, s34, 33664
  s_nop 0
  buffer_load_dwordx4 v55, s[8:11], s29 offen offset:128 nt lds
  s_add_u32 m0, s34, 33792
  s_nop 0
  buffer_load_dwordx4 v55, s[8:11], s29 offen offset:1024 nt lds
  s_add_u32 m0, s34, 34688
  s_nop 0
  buffer_load_dwordx4 v55, s[8:11], s29 offen offset:1152 nt lds
  s_waitcnt vmcnt(5)
  ds_read_b128 v[36:39], v57 offset:36864
  ds_read_b128 v[40:43], v57 offset:37888
  ds_read_b128 v[44:47], v57 offset:38912
  ds_read_b128 v[48:51], v57 offset:39936
  s_waitcnt lgkmcnt(0)
  s_mov_b64 exec, 0x110
  s_cmp_eq_u32 s3, 1
  s_cselect_b32 s50, 0x800000, 0
  buffer_store_byte v2, v2, s[48:51], s93 offen offset:3200
  s_mov_b64 exec, -1
  v_smfmac_f32_16x16x64_bf16 v[24:27], v[16:19], v[36:43], v53 abid:1
  v_smfmac_f32_16x16x64_bf16 v[24:27], v[20:23], v[44:51], v53 abid:1
  s_add_u32 s29, s71, 0x4008800
  s_add_u32 m0, s34, 36864
  s_nop 0
  buffer_load_dwordx4 v55, s[8:11], s29 offen offset:0  lds
  s_add_u32 m0, s34, 37760
  s_nop 0
  buffer_load_dwordx4 v55, s[8:11], s29 offen offset:128  lds
  s_add_u32 m0, s34, 37888
  s_nop 0
  buffer_load_dwordx4 v55, s[8:11], s29 offen offset:1024  lds
  s_add_u32 m0, s34, 38784
  s_nop 0
  buffer_load_dwordx4 v55, s[8:11], s29 offen offset:1152  lds
  v_add_f32 v58, v24, v26
  v_add_f32 v59, v25, v27
  s_nop 1
  v_add_f32_dpp v6, v59, v58 quad_perm:[1,0,3,2] row_mask:0xf bank_mask:0xf
  v_mov_b64 v[24:25], 0
  v_mov_b64 v[26:27], 0
  s_waitcnt vmcnt(5)
  ds_read_b128 v[36:39], v57 offset:32768
  ds_read_b128 v[40:43], v57 offset:33792
  ds_read_b128 v[44:47], v57 offset:34816
  ds_read_b128 v[48:51], v57 offset:35840
  s_waitcnt lgkmcnt(0)
  v_smfmac_f32_16x16x64_bf16 v[24:27], v[8:11], v[36:43], v53 abid:1
  v_smfmac_f32_16x16x64_bf16 v[24:27], v[12:15], v[44:51], v53 abid:1
  s_add_u32 s29, s72, 0x4010000
  s_add_u32 m0, s34, 32768
  s_nop 0
  buffer_load_dwordx4 v55, s[8:11], s29 offen offset:0  lds
  s_add_u32 m0, s34, 33664
  s_nop 0
  buffer_load_dwordx4 v55, s[8:11], s29 offen offset:128  lds
  s_add_u32 m0, s34, 33792
  s_nop 0
  buffer_load_dwordx4 v55, s[8:11], s29 offen offset:1024  lds
  s_add_u32 m0, s34, 34688
  s_nop 0
  buffer_load_dwordx4 v55, s[8:11], s29 offen offset:1152  lds
  s_waitcnt vmcnt(4)
  ds_read_b128 v[36:39], v57 offset:36864
  ds_read_b128 v[40:43], v57 offset:37888
  ds_read_b128 v[44:47], v57 offset:38912
  ds_read_b128 v[48:51], v57 offset:39936
  s_waitcnt lgkmcnt(0)
  v_smfmac_f32_16x16x64_bf16 v[24:27], v[16:19], v[36:43], v53 abid:1
  v_smfmac_f32_16x16x64_bf16 v[24:27], v[20:23], v[44:51], v53 abid:1
  s_add_u32 s29, s72, 0x4010800
  s_add_u32 m0, s34, 36864
  s_nop 0
  buffer_load_dwordx4 v55, s[8:11], s29 offen offset:0  lds
  s_add_u32 m0, s34, 37760
  s_nop 0
  buffer_load_dwordx4 v55, s[8:11], s29 offen offset:128  lds
  s_add_u32 m0, s34, 37888
  s_nop 0
  buffer_load_dwordx4 v55, s[8:11], s29 offen offset:1024  lds
  s_add_u32 m0, s34, 38784
  s_nop 0
  buffer_load_dwordx4 v55, s[8:11], s29 offen offset:1152  lds
  v_add_f32 v58, v24, v26
  v_add_f32 v59, v25, v27
  s_nop 1
  v_add_f32_dpp v59, v58, v59 quad_perm:[1,0,3,2] row_mask:0xf bank_mask:0xf
  v_cndmask_b32 v6, v6, v59, s[96:97]
  v_mov_b64 v[24:25], 0
  v_mov_b64 v[26:27], 0
  s_waitcnt vmcnt(4)
  ds_read_b128 v[36:39], v57 offset:32768
  ds_read_b128 v[40:43], v57 offset:33792
  ds_read_b128 v[44:47], v57 offset:34816
  ds_read_b128 v[48:51], v57 offset:35840
  s_waitcnt lgkmcnt(0)
  v_smfmac_f32_16x16x64_bf16 v[24:27], v[8:11], v[36:43], v53 abid:1
  v_smfmac_f32_16x16x64_bf16 v[24:27], v[12:15], v[44:51], v53 abid:1
  s_add_u32 s29, s73, 0x4018000
  s_add_u32 m0, s34, 32768
  s_nop 0
  buffer_load_dwordx4 v55, s[8:11], s29 offen offset:0  lds
  s_add_u32 m0, s34, 33664
  s_nop 0
  buffer_load_dwordx4 v55, s[8:11], s29 offen offset:128  lds
  s_add_u32 m0, s34, 33792
  s_nop 0
  buffer_load_dwordx4 v55, s[8:11], s29 offen offset:1024  lds
  s_add_u32 m0, s34, 34688
  s_nop 0
  buffer_load_dwordx4 v55, s[8:11], s29 offen offset:1152  lds
  s_waitcnt vmcnt(4)
  ds_read_b128 v[36:39], v57 offset:36864
  ds_read_b128 v[40:43], v57 offset:37888
  ds_read_b128 v[44:47], v57 offset:38912
  ds_read_b128 v[48:51], v57 offset:39936
  s_waitcnt lgkmcnt(0)
  v_smfmac_f32_16x16x64_bf16 v[24:27], v[16:19], v[36:43], v53 abid:1
  v_smfmac_f32_16x16x64_bf16 v[24:27], v[20:23], v[44:51], v53 abid:1
  s_add_u32 s29, s73, 0x4018800
  s_add_u32 m0, s34, 36864
  s_nop 0
  buffer_load_dwordx4 v55, s[8:11], s29 offen offset:0  lds
  s_add_u32 m0, s34, 37760
  s_nop 0
  buffer_load_dwordx4 v55, s[8:11], s29 offen offset:128  lds
  s_add_u32 m0, s34, 37888
  s_nop 0
  buffer_load_dwordx4 v55, s[8:11], s29 offen offset:1024  lds
  s_add_u32 m0, s34, 38784
  s_nop 0
  buffer_load_dwordx4 v55, s[8:11], s29 offen offset:1152  lds
  v_add_f32 v58, v24, v26
  v_add_f32 v59, v25, v27
  s_nop 1
  v_add_f32_dpp v7, v59, v58 quad_perm:[1,0,3,2] row_mask:0xf bank_mask:0xf
  v_mov_b64 v[24:25], 0
  v_mov_b64 v[26:27], 0
  s_waitcnt vmcnt(4)
  ds_read_b128 v[36:39], v57 offset:32768
  ds_read_b128 v[40:43], v57 offset:33792
  ds_read_b128 v[44:47], v57 offset:34816
  ds_read_b128 v[48:51], v57 offset:35840
  s_waitcnt lgkmcnt(0)
  v_smfmac_f32_16x16x64_bf16 v[24:27], v[8:11], v[36:43], v53 abid:1
  v_smfmac_f32_16x16x64_bf16 v[24:27], v[12:15], v[44:51], v53 abid:1
  s_add_u32 s29, s74, 0x4020000
  s_add_u32 m0, s34, 32768
  s_nop 0
  buffer_load_dwordx4 v55, s[8:11], s29 offen offset:0  lds
  s_add_u32 m0, s34, 33664
  s_nop 0
  buffer_load_dwordx4 v55, s[8:11], s29 offen offset:128  lds
  s_add_u32 m0, s34, 33792
  s_nop 0
  buffer_load_dwordx4 v55, s[8:11], s29 offen offset:1024  lds
  s_add_u32 m0, s34, 34688
  s_nop 0
  buffer_load_dwordx4 v55, s[8:11], s29 offen offset:1152  lds
  s_waitcnt vmcnt(4)
  ds_read_b128 v[36:39], v57 offset:36864
  ds_read_b128 v[40:43], v57 offset:37888
  ds_read_b128 v[44:47], v57 offset:38912
  ds_read_b128 v[48:51], v57 offset:39936
  s_waitcnt lgkmcnt(0)
  v_smfmac_f32_16x16x64_bf16 v[24:27], v[16:19], v[36:43], v53 abid:1
  v_smfmac_f32_16x16x64_bf16 v[24:27], v[20:23], v[44:51], v53 abid:1
  s_add_u32 s29, s74, 0x4020800
  s_add_u32 m0, s34, 36864
  s_nop 0
  buffer_load_dwordx4 v55, s[8:11], s29 offen offset:0  lds
  s_add_u32 m0, s34, 37760
  s_nop 0
  buffer_load_dwordx4 v55, s[8:11], s29 offen offset:128  lds
  s_add_u32 m0, s34, 37888
  s_nop 0
  buffer_load_dwordx4 v55, s[8:11], s29 offen offset:1024  lds
  s_add_u32 m0, s34, 38784
  s_nop 0
  buffer_load_dwordx4 v55, s[8:11], s29 offen offset:1152  lds
  v_add_f32 v58, v24, v26
  v_add_f32 v59, v25, v27
  s_nop 1
  v_add_f32_dpp v59, v58, v59 quad_perm:[1,0,3,2] row_mask:0xf bank_mask:0xf
  v_cndmask_b32 v7, v7, v59, s[96:97]
  v_mov_b64 v[24:25], 0
  v_mov_b64 v[26:27], 0
  s_waitcnt vmcnt(4)
  ds_read_b128 v[36:39], v57 offset:32768
  ds_read_b128 v[40:43], v57 offset:33792
  ds_read_b128 v[44:47], v57 offset:34816
  ds_read_b128 v[48:51], v57 offset:35840
  s_waitcnt lgkmcnt(0)
  buffer_load_dwordx4 v[32:35], v4, s[16:19], s36 offen sc1
  v_lshlrev_b32 v58, 2, v2
  s_add_u32 s29, s69, 4096
  buffer_load_dword v0, v58, s[16:19], s29 offen
  v_smfmac_f32_16x16x64_bf16 v[24:27], v[8:11], v[36:43], v53 abid:1
  v_smfmac_f32_16x16x64_bf16 v[24:27], v[12:15], v[44:51], v53 abid:1
  s_add_u32 s29, s75, 0x4028000
  s_add_u32 m0, s34, 32768
  s_nop 0
  buffer_load_dwordx4 v55, s[8:11], s29 offen offset:0 nt lds
  s_add_u32 m0, s34, 33664
  s_nop 0
  buffer_load_dwordx4 v55, s[8:11], s29 offen offset:128 nt lds
  s_add_u32 m0, s34, 33792
  s_nop 0
  buffer_load_dwordx4 v55, s[8:11], s29 offen offset:1024 nt lds
  s_add_u32 m0, s34, 34688
  s_nop 0
  buffer_load_dwordx4 v55, s[8:11], s29 offen offset:1152 nt lds
  s_waitcnt vmcnt(6)
  ds_read_b128 v[36:39], v57 offset:36864
  ds_read_b128 v[40:43], v57 offset:37888
  ds_read_b128 v[44:47], v57 offset:38912
  ds_read_b128 v[48:51], v57 offset:39936
  s_waitcnt vmcnt(5)
  v_max3_u32 v58, v32, v33, v34
  v_max_u32 v58, v58, v35
  v_cmp_eq_u32 vcc, -1, v58
  s_cmp_eq_u64 vcc, 0
  s_cselect_b32 s61, 4, 0
  s_add_u32 s92, s92, s61
  s_cmp_lg_u32 s92, 0
  s_waitcnt lgkmcnt(0)
  s_cbranch_scc1 L_qe_65
  buffer_load_dwordx4 v[32:35], v4, s[16:19], s36 offen sc1
L_qe_65:
  v_smfmac_f32_16x16x64_bf16 v[24:27], v[16:19], v[36:43], v53 abid:1
  v_smfmac_f32_16x16x64_bf16 v[24:27], v[20:23], v[44:51], v53 abid:1
  s_add_u32 s29, s75, 0x4028800
  s_add_u32 m0, s34, 36864
  s_nop 0
  buffer_load_dwordx4 v55, s[8:11], s29 offen offset:0 nt lds
  s_add_u32 m0, s34, 37760
  s_nop 0
  buffer_load_dwordx4 v55, s[8:11], s29 offen offset:128 nt lds
  s_add_u32 m0, s34, 37888
  s_nop 0
  buffer_load_dwordx4 v55, s[8:11], s29 offen offset:1024 nt lds
  s_add_u32 m0, s34, 38784
  s_nop 0
  buffer_load_dwordx4 v55, s[8:11], s29 offen offset:1152 nt lds
  v_add_f32 v58, v24, v26
  v_add_f32 v59, v25, v27
  s_nop 1
  v_add_f32_dpp v56, v59, v58 quad_perm:[1,0,3,2] row_mask:0xf bank_mask:0xf
  ds_read_b128 v[36:39], v57 offset:0
  ds_read_b128 v[40:43], v57 offset:1024
  ds_read_b128 v[44:47], v57 offset:2048
  ds_read_b128 v[48:51], v57 offset:3072
  v_mov_b64 v[24:25], 0
  v_mov_b64 v[26:27], 0
  v_mov_b64 v[28:29], 0
  v_mov_b64 v[30:31], 0
  s_waitcnt lgkmcnt(0)
  s_mov_b32 s30, 1
  s_add_u32 s36, s33, 8192
  s_add_u32 s92, s92, 3
  s_cmp_gt_u32 s92, 3
  s_cbranch_scc1 L_C2
  s_waitcnt vmcnt(4)
  v_max3_u32 v58, v32, v33, v34
  v_max_u32 v58, v58, v35
  v_cmp_eq_u32 vcc, -1, v58
  s_nop 0
  s_cbranch_vccz L_C2
  s_mov_b32 s92, 0
  buffer_load_dwordx4 v[32:35], v4, s[16:19], s36 offen sc1
  s_add_u32 s29, s28, 0x4000000
  buffer_load_dword v0, v2, s[12:15], s29 offen offset:0
  s_waitcnt vmcnt(5)
  buffer_load_dword v0, v2, s[12:15], s29 offen offset:1024
  s_waitcnt vmcnt(5)
  buffer_load_dword v0, v2, s[12:15], s29 offen offset:2048
  s_waitcnt vmcnt(5)
  buffer_load_dword v0, v2, s[12:15], s29 offen offset:3072
  s_waitcnt vmcnt(4)
  v_max3_u32 v58, v32, v33, v34
  v_max_u32 v58, v58, v35
  v_cmp_eq_u32 vcc, -1, v58
  s_nop 0
  s_cbranch_vccz L_C2
  s_mov_b32 s61, 0
L_pqa:
  buffer_load_dwordx4 v[32:35], v4, s[16:19], s36 offen sc1
  s_waitcnt vmcnt(0)
  v_max3_u32 v58, v32, v33, v34
  v_max_u32 v58, v58, v35
  v_cmp_eq_u32 vcc, -1, v58
  s_nop 0
  s_cbranch_vccz L_C2
  s_add_u32 s61, s61, 1
  s_cmp_gt_u32 s61, 20000
  s_cbranch_scc1 L_C2
  s_sleep 1
  s_branch L_pqa
L_C2:
  v_cndmask_b32 v8, 0, v32, s[52:53]
  v_cndmask_b32 v9, 0, v33, s[52:53]
  v_cndmask_b32 v10, 0, v34, s[52:53]
  v_cndmask_b32 v11, 0, v35, s[52:53]
  v_cndmask_b32 v12, 0, v32, s[54:55]
  v_cndmask_b32 v13, 0, v33, s[54:55]
L_C2b:
  v_smfmac_f32_16x16x64_bf16 v[24:27], v[8:11], v[64:71], v53 abid:1
  s_nop 1
  v_cndmask_b32 v14, 0, v34, s[54:55]
  v_cndmask_b32 v15, 0, v35, s[54:55]
  v_smfmac_f32_16x16x64_bf16 v[28:31], v[8:11], v[36:43], v53 abid:1
  s_nop 0
  ds_read_b128 v[36:39], v57 offset:8192
  v_cndmask_b32 v16, 0, v32, s[56:57]
  v_cndmask_b32 v17, 0, v33, s[56:57]
  v_smfmac_f32_16x16x64_bf16 v[24:27], v[12:15], v[72:79], v53 abid:1
  s_nop 0
  ds_read_b128 v[40:43], v57 offset:9216
  v_cndmask_b32 v18, 0, v34, s[56:57]
  v_cndmask_b32 v19, 0, v35, s[56:57]
  v_smfmac_f32_16x16x64_bf16 v[28:31], v[12:15], v[44:51], v53 abid:1
  s_nop 0
  ds_read_b128 v[44:47], v57 offset:10240
  v_cndmask_b32 v20, 0, v32, s[58:59]
  v_cndmask_b32 v21, 0, v33, s[58:59]
  v_cndmask_b32 v22, 0, v34, s[58:59]
  v_cndmask_b32 v23, 0, v35, s[58:59]
  v_smfmac_f32_16x16x64_bf16 v[24:27], v[16:19], v[96:103], v53 abid:1
  s_cmp_eq_u32 s30, 1
  s_nop 0
  ds_read_b128 v[48:51], v57 offset:11264
  v_smfmac_f32_16x16x64_bf16 v[24:27], v[20:23], v[104:111], v53 abid:1
  s_cbranch_scc1 L_cl_66
  s_waitcnt vmcnt(0)
L_cl_66r:
  v_smfmac_f32_16x16x64_bf16 v[28:31], v[16:19], a[64:71], v53 abid:1
  s_nop 1
  v_mov_b32 v32, 0x7f800000
  v_smfmac_f32_16x16x64_bf16 v[28:31], v[20:23], a[72:79], v53 abid:1
  s_nop 1
  v_add_f32 v58, v24, v26
  v_add_f32 v59, v25, v27
  v_smfmac_f32_16x16x64_bf16 v[24:27], v[8:11], v[128:135], v53 abid:1
  s_nop 1
  v_add_f32_dpp v60, v59, v58 quad_perm:[1,0,3,2] row_mask:0xf bank_mask:0xf
  v_smfmac_f32_16x16x64_bf16 v[24:27], v[12:15], v[136:143], v53 abid:1
  s_nop 1
  v_add_f32 v58, v28, v30
  v_smfmac_f32_16x16x64_bf16 v[24:27], v[16:19], v[160:167], v53 abid:1
  s_nop 1
  v_add_f32 v59, v29, v31
  v_smfmac_f32_16x16x64_bf16 v[24:27], v[20:23], v[168:175], v53 abid:1
  s_waitcnt lgkmcnt(2)
  s_nop 0
  v_add_f32_dpp v59, v58, v59 quad_perm:[1,0,3,2] row_mask:0xf bank_mask:0xf
  v_smfmac_f32_16x16x64_bf16 v[28:31], v[8:11], v[36:43], v53 abid:1
  s_waitcnt lgkmcnt(0)
  ds_read_b128 v[36:39], v57 offset:16384
  v_cndmask_b32 v60, v60, v59, s[96:97]
  v_smfmac_f32_16x16x64_bf16 v[28:31], v[12:15], v[44:51], v53 abid:1
  s_nop 0
  ds_read_b128 v[40:43], v57 offset:17408
  v_add_f32 v58, v24, v26
  v_smfmac_f32_16x16x64_bf16 v[28:31], v[16:19], a[96:103], v53 abid:1
  s_nop 0
  ds_read_b128 v[44:47], v57 offset:18432
  v_add_f32 v59, v25, v27
  v_smfmac_f32_16x16x64_bf16 v[28:31], v[20:23], a[104:111], v53 abid:1
  s_nop 0
  ds_read_b128 v[48:51], v57 offset:19456
  v_add_f32_dpp v5, v59, v58 quad_perm:[1,0,3,2] row_mask:0xf bank_mask:0xf
  v_smfmac_f32_16x16x64_bf16 v[24:27], v[8:11], v[192:199], v53 abid:1
  s_nop 2
  v_smfmac_f32_16x16x64_bf16 v[24:27], v[12:15], v[200:207], v53 abid:1
  s_nop 1
  v_add_f32 v58, v28, v30
  v_smfmac_f32_16x16x64_bf16 v[24:27], v[16:19], v[224:231], v53 abid:1
  s_nop 1
  v_add_f32 v59, v29, v31
  v_smfmac_f32_16x16x64_bf16 v[24:27], v[20:23], v[232:239], v53 abid:1
  s_waitcnt lgkmcnt(2)
  s_nop 0
  v_add_f32_dpp v59, v58, v59 quad_perm:[1,0,3,2] row_mask:0xf bank_mask:0xf
  v_smfmac_f32_16x16x64_bf16 v[28:31], v[8:11], v[36:43], v53 abid:1
  s_waitcnt lgkmcnt(0)
  ds_read_b128 v[36:39], v57 offset:24576
  v_cndmask_b32 v5, v5, v59, s[96:97]
  v_smfmac_f32_16x16x64_bf16 v[28:31], v[12:15], v[44:51], v53 abid:1
  s_nop 0
  ds_read_b128 v[40:43], v57 offset:25600
  v_add_f32 v58, v24, v26
  v_smfmac_f32_16x16x64_bf16 v[28:31], v[16:19], a[128:135], v53 abid:1
  s_nop 0
  ds_read_b128 v[44:47], v57 offset:26624
  v_add_f32 v59, v25, v27
  v_smfmac_f32_16x16x64_bf16 v[28:31], v[20:23], a[136:143], v53 abid:1
  s_nop 0
  ds_read_b128 v[48:51], v57 offset:27648
  v_add_f32_dpp v63, v59, v58 quad_perm:[1,0,3,2] row_mask:0xf bank_mask:0xf
  v_smfmac_f32_16x16x64_bf16 v[24:27], v[8:11], a[0:7], v53 abid:1
  s_nop 1
  v_sub_f32 v61, v5, v60
  v_smfmac_f32_16x16x64_bf16 v[24:27], v[12:15], a[8:15], v53 abid:1
  s_nop 1
  v_add_f32 v58, v28, v30
  v_smfmac_f32_16x16x64_bf16 v[24:27], v[16:19], a[32:39], v53 abid:1
  s_nop 1
  v_add_f32 v59, v29, v31
  v_smfmac_f32_16x16x64_bf16 v[24:27], v[20:23], a[40:47], v53 abid:1
  s_waitcnt lgkmcnt(2)
  s_nop 0
  v_add_f32_dpp v59, v58, v59 quad_perm:[1,0,3,2] row_mask:0xf bank_mask:0xf
  v_smfmac_f32_16x16x64_bf16 v[28:31], v[8:11], v[36:43], v53 abid:1
  s_waitcnt lgkmcnt(0)
  ds_read_b128 v[36:39], v3 offset:4096
  v_cndmask_b32 v63, v63, v59, s[96:97]
  v_smfmac_f32_16x16x64_bf16 v[28:31], v[12:15], v[44:51], v53 abid:1
  s_nop 0
  ds_read_b128 v[40:43], v3 offset:5120
  v_add_f32 v58, v24, v26
  v_smfmac_f32_16x16x64_bf16 v[28:31], v[16:19], a[160:167], v53 abid:1
  s_nop 0
  ds_read_b128 v[44:47], v3 offset:6144
  v_add_f32 v59, v25, v27
  v_smfmac_f32_16x16x64_bf16 v[28:31], v[20:23], a[168:175], v53 abid:1
  s_nop 0
  ds_read_b128 v[48:51], v3 offset:7168
  v_sub_f32 v62, v63, v5
  v_smfmac_f32_16x16x64_bf16 v[24:27], v[8:11], a[192:199], v53 abid:1
  s_nop 1
  v_add_f32_dpp v5, v59, v58 quad_perm:[1,0,3,2] row_mask:0xf bank_mask:0xf
  v_smfmac_f32_16x16x64_bf16 v[24:27], v[12:15], a[200:207], v53 abid:1
  s_nop 1
  v_add_f32 v58, v28, v30
  v_smfmac_f32_16x16x64_bf16 v[24:27], v[16:19], a[224:231], v53 abid:1
  s_nop 1
  v_add_f32 v59, v29, v31
  v_smfmac_f32_16x16x64_bf16 v[24:27], v[20:23], a[232:239], v53 abid:1
  s_cbranch_scc1 L_cl_67
L_cl_67r:
  v_add_f32_dpp v59, v58, v59 quad_perm:[1,0,3,2] row_mask:0xf bank_mask:0xf
  v_cndmask_b32 v5, v5, v59, s[96:97]
  v_sub_f32 v63, v5, v63
  v_cndmask_b32 v5, v5, v32, s[96:97]
  v_max3_f32 v28, v60, v61, v62
  v_mov_b64 v[22:23], 0
  v_mov_b64 v[20:21], 0
  v_add_f32 v58, v24, v26
  v_add_f32 v59, v25, v27
  v_sub_f32 v58, v58, v5
  v_mov_b64 v[18:19], 0
  v_mov_b64 v[16:17], 0
  v_add_f32_dpp v5, v59, v58 quad_perm:[1,0,3,2] row_mask:0xf bank_mask:0xf
  v_max3_f32 v24, v28, v63, v5
  v_mov_b64 v[14:15], 0
  v_mov_b64 v[12:13], 0
  v_max_f32_dpp v24, v24, v24 row_ror:8 row_mask:0xf bank_mask:0xf
  v_mov_b64 v[10:11], 0
  v_mov_b64 v[8:9], 0
  v_max_f32_dpp v24, v24, v24 row_ror:4 row_mask:0xf bank_mask:0xf
  v_lshrrev_b32 v27, 2, v2
  v_lshlrev_b32 v32, 22, v2
  v_max_f32_dpp v24, v24, v24 row_ror:2 row_mask:0xf bank_mask:0xf
  v_lshrrev_b32 v33, 5, v2
  v_and_b32 v32, 0x3c000000, v32
  v_max_f32_dpp v24, v24, v24 row_ror:1 row_mask:0xf bank_mask:0xf
  v_mov_b32 v26, v24
  v_add3_u32 v32, v32, v33, s24
  s_nop 0
  v_permlane32_swap_b32 v24, v26
  v_max_f32 v24, v24, v26
  v_mov_b32 v26, v24
  s_nop 1
  v_permlane16_swap_b32 v24, v26
  v_max_f32 v24, v24, v26
  v_mul_f32 v24, s60, v24
  v_fma_f32 v60, v60, s60, -v24
  v_fma_f32 v61, v61, s60, -v24
  v_fma_f32 v62, v62, s60, -v24
  v_fma_f32 v63, v63, s60, -v24
  v_fma_f32 v5, v5, s60, -v24
  v_exp_f32 v60, v60
  v_exp_f32 v61, v61
  v_exp_f32 v62, v62
  v_exp_f32 v63, v63
  v_exp_f32 v5, v5
  v_add_f32 v25, v60, v61
  v_cvt_pk_bf16_f32 v60, v60, 0
  v_cvt_pk_bf16_f32 v61, v61, 0
  v_add_f32 v25, v25, v62
  v_cvt_pk_bf16_f32 v62, v62, 0
  v_add_f32 v25, v25, v63
  v_cvt_pk_bf16_f32 v63, v63, 0
  v_add_f32 v25, v25, v5
  v_cvt_pk_bf16_f32 v5, v5, 0
  v_mov_b32_dpp v8, v63 quad_perm:[0,0,0,0] row_mask:0xf bank_mask:0x3
  v_mov_b32_dpp v10, v63 quad_perm:[2,2,2,2] row_mask:0xf bank_mask:0x3
  v_add_f32_dpp v25, v25, v25 row_ror:8 row_mask:0xf bank_mask:0xf
  v_mov_b32_dpp v9, v8 row_ror:8 row_mask:0xf bank_mask:0xc
  v_mov_b32_dpp v11, v10 row_ror:8 row_mask:0xf bank_mask:0xc
  v_add_f32_dpp v25, v25, v25 row_ror:4 row_mask:0xf bank_mask:0xf
  v_mov_b32_dpp v13, v63 quad_perm:[0,0,0,0] row_mask:0xf bank_mask:0xc
  v_smfmac_f32_16x16x64_bf16 v[16:19], v[8:11], a[16:23], v53
  v_mov_b32_dpp v15, v63 quad_perm:[2,2,2,2] row_mask:0xf bank_mask:0xc
  v_add_f32_dpp v25, v25, v25 row_ror:2 row_mask:0xf bank_mask:0xf
  v_mov_b32_dpp v12, v13 row_ror:8 row_mask:0xf bank_mask:0x3
  v_mov_b32_dpp v14, v15 row_ror:8 row_mask:0xf bank_mask:0x3
  v_smfmac_f32_16x16x64_bf16 v[20:23], v[8:11], a[24:31], v53
  v_add_f32_dpp v25, v25, v25 row_ror:1 row_mask:0xf bank_mask:0xf
  v_mov_b32_dpp v8, v60 quad_perm:[1,1,1,1] row_mask:0xf bank_mask:0x3
  v_mov_b32_dpp v10, v60 quad_perm:[3,3,3,3] row_mask:0xf bank_mask:0x3
  v_smfmac_f32_16x16x64_bf16 v[16:19], v[12:15], a[48:55], v53
  buffer_store_dwordx2 v[24:25], v32, s[40:43], s32 offen
  v_mov_b32_dpp v9, v8 row_ror:8 row_mask:0xf bank_mask:0xc
  v_mov_b32_dpp v11, v10 row_ror:8 row_mask:0xf bank_mask:0xc
  v_smfmac_f32_16x16x64_bf16 v[20:23], v[12:15], a[56:63], v53
  s_waitcnt lgkmcnt(2)
  buffer_store_dwordx2 v[24:25], v32, s[44:47], s32 offen sc1
  v_mov_b32_dpp v13, v60 quad_perm:[1,1,1,1] row_mask:0xf bank_mask:0xc
  v_mov_b32_dpp v15, v60 quad_perm:[3,3,3,3] row_mask:0xf bank_mask:0xc
  v_smfmac_f32_16x16x64_bf16 v[16:19], v[8:11], v[36:43], v53
  s_waitcnt lgkmcnt(0)
  ds_read_b128 v[36:39], v3 offset:12288
  v_mov_b32_dpp v12, v13 row_ror:8 row_mask:0xf bank_mask:0x3
  v_mov_b32_dpp v14, v15 row_ror:8 row_mask:0xf bank_mask:0x3
  v_smfmac_f32_16x16x64_bf16 v[20:23], v[8:11], v[44:51], v53
  ds_read_b128 v[40:43], v3 offset:13312
  v_mov_b32_dpp v9, v61 quad_perm:[1,1,1,1] row_mask:0xf bank_mask:0xc
  v_mov_b32_dpp v11, v61 quad_perm:[3,3,3,3] row_mask:0xf bank_mask:0xc
  v_smfmac_f32_16x16x64_bf16 v[16:19], v[12:15], a[80:87], v53
  ds_read_b128 v[44:47], v3 offset:14336
  v_mov_b32_dpp v8, v9 row_ror:8 row_mask:0xf bank_mask:0x3
  v_mov_b32_dpp v10, v11 row_ror:8 row_mask:0xf bank_mask:0x3
  v_smfmac_f32_16x16x64_bf16 v[20:23], v[12:15], a[88:95], v53
  ds_read_b128 v[48:51], v3 offset:15360
  v_mov_b32_dpp v13, v62 quad_perm:[1,1,1,1] row_mask:0xf bank_mask:0xc
  v_mov_b32_dpp v15, v62 quad_perm:[3,3,3,3] row_mask:0xf bank_mask:0xc
  v_smfmac_f32_16x16x64_bf16 v[16:19], v[8:11], a[112:119], v53
  v_mov_b32_dpp v12, v13 row_ror:8 row_mask:0xf bank_mask:0x3
  v_mov_b32_dpp v14, v15 row_ror:8 row_mask:0xf bank_mask:0x3
  v_smfmac_f32_16x16x64_bf16 v[20:23], v[8:11], a[120:127], v53
  v_mov_b32_dpp v8, v61 quad_perm:[1,1,1,1] row_mask:0xf bank_mask:0x3
  v_mov_b32_dpp v10, v61 quad_perm:[3,3,3,3] row_mask:0xf bank_mask:0x3
  v_smfmac_f32_16x16x64_bf16 v[16:19], v[12:15], a[144:151], v53
  v_mov_b32_dpp v9, v8 row_ror:8 row_mask:0xf bank_mask:0xc
  v_mov_b32_dpp v11, v10 row_ror:8 row_mask:0xf bank_mask:0xc
  v_smfmac_f32_16x16x64_bf16 v[20:23], v[12:15], a[152:159], v53
  s_waitcnt lgkmcnt(2)
  v_mov_b32_dpp v13, v63 quad_perm:[1,1,1,1] row_mask:0xf bank_mask:0xc
  v_mov_b32_dpp v15, v63 quad_perm:[3,3,3,3] row_mask:0xf bank_mask:0xc
  v_smfmac_f32_16x16x64_bf16 v[16:19], v[8:11], v[36:43], v53
  s_waitcnt lgkmcnt(0)
  ds_read_b128 v[36:39], v3 offset:20480
  v_mov_b32_dpp v12, v13 row_ror:8 row_mask:0xf bank_mask:0x3
  v_mov_b32_dpp v14, v15 row_ror:8 row_mask:0xf bank_mask:0x3
  v_smfmac_f32_16x16x64_bf16 v[20:23], v[8:11], v[44:51], v53
  ds_read_b128 v[40:43], v3 offset:21504
  v_mov_b32_dpp v8, v5 quad_perm:[0,0,0,0] row_mask:0xf bank_mask:0x3
  v_mov_b32_dpp v10, v5 quad_perm:[2,2,2,2] row_mask:0xf bank_mask:0x3
  v_smfmac_f32_16x16x64_bf16 v[16:19], v[12:15], a[176:183], v53
  ds_read_b128 v[44:47], v3 offset:22528
  v_mov_b32_dpp v9, v8 row_ror:8 row_mask:0xf bank_mask:0xc
  v_mov_b32_dpp v11, v10 row_ror:8 row_mask:0xf bank_mask:0xc
  v_smfmac_f32_16x16x64_bf16 v[20:23], v[12:15], a[184:191], v53
  ds_read_b128 v[48:51], v3 offset:23552
  v_mov_b32_dpp v13, v5 quad_perm:[0,0,0,0] row_mask:0xf bank_mask:0xc
  v_mov_b32_dpp v15, v5 quad_perm:[2,2,2,2] row_mask:0xf bank_mask:0xc
  v_smfmac_f32_16x16x64_bf16 v[16:19], v[8:11], a[208:215], v53
  v_mov_b32_dpp v12, v13 row_ror:8 row_mask:0xf bank_mask:0x3
  v_mov_b32_dpp v14, v15 row_ror:8 row_mask:0xf bank_mask:0x3
  v_smfmac_f32_16x16x64_bf16 v[20:23], v[8:11], a[216:223], v53
  v_mov_b32_dpp v8, v62 quad_perm:[1,1,1,1] row_mask:0xf bank_mask:0x3
  v_mov_b32_dpp v10, v62 quad_perm:[3,3,3,3] row_mask:0xf bank_mask:0x3
  v_smfmac_f32_16x16x64_bf16 v[16:19], v[12:15], a[240:247], v53
  v_mov_b32_dpp v9, v8 row_ror:8 row_mask:0xf bank_mask:0xc
  v_mov_b32_dpp v11, v10 row_ror:8 row_mask:0xf bank_mask:0xc
  v_smfmac_f32_16x16x64_bf16 v[20:23], v[12:15], a[248:255], v53
  s_waitcnt lgkmcnt(2)
  v_mov_b32_dpp v12, v60 quad_perm:[0,0,0,0] row_mask:0xf bank_mask:0x3
  v_mov_b32_dpp v14, v60 quad_perm:[2,2,2,2] row_mask:0xf bank_mask:0x3
  v_smfmac_f32_16x16x64_bf16 v[16:19], v[8:11], v[36:43], v53
  s_waitcnt lgkmcnt(0)
  ds_read_b128 v[36:39], v3 offset:28672
  v_mov_b32_dpp v13, v12 row_ror:8 row_mask:0xf bank_mask:0xc
  v_mov_b32_dpp v15, v14 row_ror:8 row_mask:0xf bank_mask:0xc
  v_smfmac_f32_16x16x64_bf16 v[20:23], v[8:11], v[44:51], v53
  ds_read_b128 v[40:43], v3 offset:29696
  v_mov_b32_dpp v9, v60 quad_perm:[0,0,0,0] row_mask:0xf bank_mask:0xc
  v_mov_b32_dpp v11, v60 quad_perm:[2,2,2,2] row_mask:0xf bank_mask:0xc
  v_smfmac_f32_16x16x64_bf16 v[16:19], v[12:15], v[80:87], v53
  ds_read_b128 v[44:47], v3 offset:30720
  v_mov_b32_dpp v8, v9 row_ror:8 row_mask:0xf bank_mask:0x3
  v_mov_b32_dpp v10, v11 row_ror:8 row_mask:0xf bank_mask:0x3
  v_smfmac_f32_16x16x64_bf16 v[20:23], v[12:15], v[88:95], v53
  ds_read_b128 v[48:51], v3 offset:31744
  v_mov_b32_dpp v12, v61 quad_perm:[0,0,0,0] row_mask:0xf bank_mask:0x3
  v_mov_b32_dpp v14, v61 quad_perm:[2,2,2,2] row_mask:0xf bank_mask:0x3
  v_smfmac_f32_16x16x64_bf16 v[16:19], v[8:11], v[112:119], v53
  v_mov_b32_dpp v13, v12 row_ror:8 row_mask:0xf bank_mask:0xc
  v_mov_b32_dpp v15, v14 row_ror:8 row_mask:0xf bank_mask:0xc
  v_smfmac_f32_16x16x64_bf16 v[20:23], v[8:11], v[120:127], v53
  v_mov_b32_dpp v8, v63 quad_perm:[1,1,1,1] row_mask:0xf bank_mask:0x3
  v_mov_b32_dpp v10, v63 quad_perm:[3,3,3,3] row_mask:0xf bank_mask:0x3
  v_smfmac_f32_16x16x64_bf16 v[16:19], v[12:15], v[144:151], v53
  v_mov_b32_dpp v9, v8 row_ror:8 row_mask:0xf bank_mask:0xc
  v_mov_b32_dpp v11, v10 row_ror:8 row_mask:0xf bank_mask:0xc
  v_smfmac_f32_16x16x64_bf16 v[20:23], v[12:15], v[152:159], v53
  s_waitcnt lgkmcnt(2)
  v_mov_b32_dpp v13, v61 quad_perm:[0,0,0,0] row_mask:0xf bank_mask:0xc
  v_mov_b32_dpp v15, v61 quad_perm:[2,2,2,2] row_mask:0xf bank_mask:0xc
  v_smfmac_f32_16x16x64_bf16 v[16:19], v[8:11], v[36:43], v53
  s_waitcnt lgkmcnt(0)
  v_mov_b32_dpp v12, v13 row_ror:8 row_mask:0xf bank_mask:0x3
  v_mov_b32_dpp v14, v15 row_ror:8 row_mask:0xf bank_mask:0x3
  v_smfmac_f32_16x16x64_bf16 v[20:23], v[8:11], v[44:51], v53
  v_mov_b32_dpp v8, v62 quad_perm:[0,0,0,0] row_mask:0xf bank_mask:0x3
  v_mov_b32_dpp v10, v62 quad_perm:[2,2,2,2] row_mask:0xf bank_mask:0x3
  v_smfmac_f32_16x16x64_bf16 v[16:19], v[12:15], v[176:183], v53
  v_mov_b32_dpp v9, v8 row_ror:8 row_mask:0xf bank_mask:0xc
  v_mov_b32_dpp v11, v10 row_ror:8 row_mask:0xf bank_mask:0xc
  v_smfmac_f32_16x16x64_bf16 v[20:23], v[12:15], v[184:191], v53
  v_mov_b32_dpp v13, v62 quad_perm:[0,0,0,0] row_mask:0xf bank_mask:0xc
  v_mov_b32_dpp v15, v62 quad_perm:[2,2,2,2] row_mask:0xf bank_mask:0xc
  v_smfmac_f32_16x16x64_bf16 v[16:19], v[8:11], v[208:215], v53
  v_mov_b32_dpp v12, v13 row_ror:8 row_mask:0xf bank_mask:0x3
  v_mov_b32_dpp v14, v15 row_ror:8 row_mask:0xf bank_mask:0x3
  v_smfmac_f32_16x16x64_bf16 v[20:23], v[8:11], v[216:223], v53
  s_nop 0
  v_smfmac_f32_16x16x64_bf16 v[16:19], v[12:15], v[240:247], v53
  v_smfmac_f32_16x16x64_bf16 v[20:23], v[12:15], v[248:255], v53
  s_nop 7
  v_permlane16_swap_b32 v16, v20
  v_permlane16_swap_b32 v18, v22
  v_permlane16_swap_b32 v17, v21
  v_add_f32_dpp v16, v20, v16 row_ror:8 row_mask:0xf bank_mask:0x3
  v_add_f32_dpp v18, v22, v18 row_ror:8 row_mask:0xf bank_mask:0x3
  v_permlane16_swap_b32 v19, v23
  v_add_f32_dpp v16, v17, v21 row_ror:8 row_mask:0xf bank_mask:0xc
  s_nop 0
  v_add_f32_dpp v18, v19, v23 row_ror:8 row_mask:0xf bank_mask:0xc
  v_cvt_pk_bf16_f32 v16, v16, v18
  buffer_store_dword v16, v27, s[40:43], s32 offen
  buffer_store_dword v16, v27, s[44:47], s32 offen sc1
  s_add_u32 s32, s32, 0x80000
  s_cmp_eq_u32 s30, 3
  s_cbranch_scc1 L_end
  s_mov_b32 s92, 0
  s_add_u32 s93, s93, 4096
  s_add_u32 s69, s69, 4096
  s_mov_b32 s68, 5
  s_buffer_load_dwordx8 s[80:87], s[16:19], s69 offset:512
  s_mov_b64 exec, 0x110
  s_cmp_eq_u32 s3, 3
  s_cselect_b32 s50, 0x800000, 0
  buffer_store_byte v2, v2, s[48:51], s93 offen offset:384
  s_mov_b64 exec, -1
  s_waitcnt vmcnt(11)
  s_cmp_gt_i32 s92, 0
  s_cbranch_scc1 L_d_68
  s_waitcnt vmcnt(8)
L_d_68:
  s_add_u32 s29, s78, 0x4040000
  buffer_load_dwordx4 v[192:195], v1, s[8:11], s29 offen offset:0 nt
  s_waitcnt vmcnt(11)
  s_cmp_gt_i32 s92, 0
  s_cbranch_scc1 L_d_69
  s_waitcnt vmcnt(8)
L_d_69:
  buffer_load_dwordx4 v[196:199], v1, s[8:11], s29 offen offset:128 nt
  s_waitcnt vmcnt(11)
  s_cmp_gt_i32 s92, 0
  s_cbranch_scc1 L_d_70
  s_waitcnt vmcnt(8)
L_d_70:
  buffer_load_dwordx4 v[200:203], v1, s[8:11], s29 offen offset:1024 nt
  s_waitcnt vmcnt(11)
  s_cmp_gt_i32 s92, 0
  s_cbranch_scc1 L_d_71
  s_waitcnt vmcnt(8)
L_d_71:
  buffer_load_dwordx4 v[204:207], v1, s[8:11], s29 offen offset:1152 nt
  buffer_load_dwordx4 v[36:39], v4, s[16:19], s26 offen sc1
  s_add_u32 s29, s28, 0x4000000
  buffer_load_dwordx4 a[16:19], v52, s[12:15], s29 offen offset:0 nt
  buffer_load_dwordx4 a[20:23], v52, s[12:15], s29 offen offset:2048 nt
  buffer_load_dwordx4 a[24:27], v52, s[12:15], s29 offen offset:128 nt
  buffer_load_dwordx4 a[28:31], v52, s[12:15], s29 offen offset:2176 nt
  s_waitcnt lgkmcnt(0)
  s_bcnt1_i32_b64 s80, s[80:81]
  s_bcnt1_i32_b64 s81, s[82:83]
  s_bcnt1_i32_b64 s82, s[84:85]
  s_bcnt1_i32_b64 s83, s[86:87]
  s_add_u32 s80, s80, s81
  s_add_u32 s82, s82, s83
  s_add_u32 s80, s80, s82
  s_cmp_ge_u32 s80, s68
  s_cselect_b32 s80, 6, 0
  s_sub_u32 s92, s92, 1
  s_cselect_b32 s92, s80, s92
  s_buffer_load_dwordx8 s[80:87], s[16:19], s69 offset:640
  s_mov_b64 exec, 0x110
  s_cmp_eq_u32 s3, 0
  s_cselect_b32 s50, 0x800000, 0
  buffer_store_byte v2, v2, s[48:51], s93 offen offset:512
  s_mov_b64 exec, -1
  s_waitcnt vmcnt(17)
  s_cmp_gt_i32 s92, 0
  s_cbranch_scc1 L_d_72
  s_waitcnt vmcnt(14)
L_d_72:
  s_add_u32 s29, s78, 0x4040800
  buffer_load_dwordx4 v[224:227], v1, s[8:11], s29 offen offset:0 nt
  s_waitcnt vmcnt(17)
  s_cmp_gt_i32 s92, 0
  s_cbranch_scc1 L_d_73
  s_waitcnt vmcnt(14)
L_d_73:
  buffer_load_dwordx4 v[228:231], v1, s[8:11], s29 offen offset:128 nt
  s_waitcnt vmcnt(17)
  s_cmp_gt_i32 s92, 0
  s_cbranch_scc1 L_d_74
  s_waitcnt vmcnt(11)
L_d_74:
  buffer_load_dwordx4 v[232:235], v1, s[8:11], s29 offen offset:1024 nt
  s_waitcnt vmcnt(17)
  s_cmp_gt_i32 s92, 0
  s_cbranch_scc1 L_d_75
  s_waitcnt vmcnt(11)
L_d_75:
  buffer_load_dwordx4 v[236:239], v1, s[8:11], s29 offen offset:1152 nt
  s_waitcnt lgkmcnt(0)
  s_bcnt1_i32_b64 s80, s[80:81]
  s_bcnt1_i32_b64 s81, s[82:83]
  s_bcnt1_i32_b64 s82, s[84:85]
  s_bcnt1_i32_b64 s83, s[86:87]
  s_add_u32 s80, s80, s81
  s_add_u32 s82, s82, s83
  s_add_u32 s80, s80, s82
  s_cmp_ge_u32 s80, s68
  s_cselect_b32 s80, 6, 0
  s_sub_u32 s92, s92, 1
  s_cselect_b32 s92, s80, s92
  s_buffer_load_dwordx8 s[80:87], s[16:19], s69 offset:768
  s_mov_b64 exec, 0x110
  s_cmp_eq_u32 s3, 1
  s_cselect_b32 s50, 0x800000, 0
  buffer_store_byte v2, v2, s[48:51], s93 offen offset:640
  s_mov_b64 exec, -1
  s_waitcnt vmcnt(18)
  s_cmp_gt_i32 s92, 0
  s_cbranch_scc1 L_d_76
  s_waitcnt vmcnt(12)
L_d_76:
  s_add_u32 s29, s28, 0x4004000
  buffer_load_dwordx4 a[48:51], v52, s[12:15], s29 offen offset:0 nt
  s_waitcnt vmcnt(15)
  s_cmp_gt_i32 s92, 0
  s_cbranch_scc1 L_d_77
  s_waitcnt vmcnt(12)
L_d_77:
  buffer_load_dwordx4 a[52:55], v52, s[12:15], s29 offen offset:2048 nt
  s_waitcnt vmcnt(15)
  s_cmp_gt_i32 s92, 0
  s_cbranch_scc1 L_d_78
  s_waitcnt vmcnt(6)
L_d_78:
  buffer_load_dwordx4 a[56:59], v52, s[12:15], s29 offen offset:128 nt
  s_waitcnt vmcnt(15)
  s_cmp_gt_i32 s92, 0
  s_cbranch_scc1 L_d_79
  s_waitcnt vmcnt(6)
L_d_79:
  buffer_load_dwordx4 a[60:63], v52, s[12:15], s29 offen offset:2176 nt
  ds_read_b128 a[192:195], v57 offset:32768
  ds_read_b128 a[196:199], v57 offset:33792
  ds_read_b128 a[200:203], v57 offset:34816
  ds_read_b128 a[204:207], v57 offset:35840
  ds_read_b128 a[224:227], v57 offset:36864
  ds_read_b128 a[228:231], v57 offset:37888
  ds_read_b128 a[232:235], v57 offset:38912
  ds_read_b128 a[236:239], v57 offset:39936
  s_waitcnt vmcnt(14)
  v_cndmask_b32 v8, 0, v36, s[52:53]
  v_cndmask_b32 v9, 0, v37, s[52:53]
  v_cndmask_b32 v10, 0, v38, s[52:53]
  v_cndmask_b32 v11, 0, v39, s[52:53]
  v_cndmask_b32 v12, 0, v36, s[54:55]
  v_cndmask_b32 v13, 0, v37, s[54:55]
  v_cndmask_b32 v14, 0, v38, s[54:55]
  v_cndmask_b32 v15, 0, v39, s[54:55]
  v_cndmask_b32 v16, 0, v36, s[56:57]
  v_cndmask_b32 v17, 0, v37, s[56:57]
  v_cndmask_b32 v18, 0, v38, s[56:57]
  v_cndmask_b32 v19, 0, v39, s[56:57]
  v_cndmask_b32 v20, 0, v36, s[58:59]
  v_cndmask_b32 v21, 0, v37, s[58:59]
  v_cndmask_b32 v22, 0, v38, s[58:59]
  v_cndmask_b32 v23, 0, v39, s[58:59]
  s_waitcnt lgkmcnt(0)
  s_bcnt1_i32_b64 s80, s[80:81]
  s_bcnt1_i32_b64 s81, s[82:83]
  s_bcnt1_i32_b64 s82, s[84:85]
  s_bcnt1_i32_b64 s83, s[86:87]
  s_add_u32 s80, s80, s81
  s_add_u32 s82, s82, s83
  s_add_u32 s80, s80, s82
  s_cmp_ge_u32 s80, s68
  s_cselect_b32 s80, 6, 0
  s_sub_u32 s92, s92, 1
  s_cselect_b32 s92, s80, s92
  s_buffer_load_dwordx8 s[80:87], s[16:19], s69 offset:896
  s_mov_b64 exec, 0x110
  s_cmp_eq_u32 s3, 2
  s_cselect_b32 s50, 0x800000, 0
  buffer_store_byte v2, v2, s[48:51], s93 offen offset:768
  s_mov_b64 exec, -1
  s_cmp_gt_i32 s92, 0
  s_cbranch_scc1 L_d_80
  s_waitcnt vmcnt(7)
L_d_80:
  s_add_u32 s29, s71, 0x4008000
  s_add_u32 m0, s34, 4096
  s_nop 0
  buffer_load_dwordx4 v52, s[12:15], s29 offen offset:0 nt lds
  s_waitcnt vmcnt(10)
  s_cmp_gt_i32 s92, 0
  s_cbranch_scc1 L_d_81
  s_waitcnt vmcnt(7)
L_d_81:
  s_add_u32 m0, s34, 3072
  s_nop 0
  buffer_load_dwordx4 v52, s[12:15], s29 offen offset:2048 nt lds
  s_waitcnt vmcnt(10)
  s_cmp_gt_i32 s92, 0
  s_cbranch_scc1 L_d_82
  s_waitcnt vmcnt(6)
L_d_82:
  s_add_u32 m0, s34, 6016
  s_nop 0
  buffer_load_dwordx4 v52, s[12:15], s29 offen offset:128 nt lds
  s_waitcnt vmcnt(10)
  s_cmp_gt_i32 s92, 0
  s_cbranch_scc1 L_d_83
  s_waitcnt vmcnt(6)
L_d_83:
  s_add_u32 m0, s34, 4992
  s_nop 0
  buffer_load_dwordx4 v52, s[12:15], s29 offen offset:2176 nt lds
  s_waitcnt lgkmcnt(0)
  s_bcnt1_i32_b64 s80, s[80:81]
  s_bcnt1_i32_b64 s81, s[82:83]
  s_bcnt1_i32_b64 s82, s[84:85]
  s_bcnt1_i32_b64 s83, s[86:87]
  s_add_u32 s80, s80, s81
  s_add_u32 s82, s82, s83
  s_add_u32 s80, s80, s82
  s_cmp_ge_u32 s80, s68
  s_cselect_b32 s80, 6, 0
  s_sub_u32 s92, s92, 1
  s_cselect_b32 s92, s80, s92
  s_buffer_load_dwordx8 s[80:87], s[16:19], s69 offset:1024
  s_mov_b64 exec, 0x110
  s_cmp_eq_u32 s3, 3
  s_cselect_b32 s50, 0x800000, 0
  buffer_store_byte v2, v2, s[48:51], s93 offen offset:896
  s_mov_b64 exec, -1
  s_waitcnt vmcnt(11)
  s_cmp_gt_i32 s92, 0
  s_cbranch_scc1 L_d_84
  s_waitcnt vmcnt(7)
L_d_84:
  s_add_u32 s29, s71, 0x400c000
  buffer_load_dwordx4 a[80:83], v52, s[12:15], s29 offen offset:0 nt
  s_waitcnt vmcnt(10)
  s_cmp_gt_i32 s92, 0
  s_cbranch_scc1 L_d_85
  s_waitcnt vmcnt(7)
L_d_85:
  buffer_load_dwordx4 a[84:87], v52, s[12:15], s29 offen offset:2048 nt
  s_waitcnt vmcnt(10)
  s_cmp_gt_i32 s92, 0
  s_cbranch_scc1 L_d_86
  s_waitcnt vmcnt(6)
L_d_86:
  buffer_load_dwordx4 a[88:91], v52, s[12:15], s29 offen offset:128 nt
  s_waitcnt vmcnt(10)
  s_cmp_gt_i32 s92, 0
  s_cbranch_scc1 L_d_87
  s_waitcnt vmcnt(6)
L_d_87:
  buffer_load_dwordx4 a[92:95], v52, s[12:15], s29 offen offset:2176 nt
  s_waitcnt lgkmcnt(0)
  s_bcnt1_i32_b64 s80, s[80:81]
  s_bcnt1_i32_b64 s81, s[82:83]
  s_bcnt1_i32_b64 s82, s[84:85]
  s_bcnt1_i32_b64 s83, s[86:87]
  s_add_u32 s80, s80, s81
  s_add_u32 s82, s82, s83
  s_add_u32 s80, s80, s82
  s_cmp_ge_u32 s80, s68
  s_cselect_b32 s80, 6, 0
  s_sub_u32 s92, s92, 1
  s_cselect_b32 s92, s80, s92
  s_buffer_load_dwordx8 s[80:87], s[16:19], s69 offset:1152
  s_mov_b64 exec, 0x110
  s_cmp_eq_u32 s3, 0
  s_cselect_b32 s50, 0x800000, 0
  buffer_store_byte v2, v2, s[48:51], s93 offen offset:1024
  s_mov_b64 exec, -1
  s_waitcnt vmcnt(11)
  s_cmp_gt_i32 s92, 0
  s_cbranch_scc1 L_d_88
  s_waitcnt vmcnt(7)
L_d_88:
  s_add_u32 s29, s72, 0x4010000
  s_add_u32 m0, s34, 12288
  s_nop 0
  buffer_load_dwordx4 v52, s[12:15], s29 offen offset:0 nt lds
  s_waitcnt vmcnt(10)
  s_cmp_gt_i32 s92, 0
  s_cbranch_scc1 L_d_89
  s_waitcnt vmcnt(7)
L_d_89:
  s_add_u32 m0, s34, 11264
  s_nop 0
  buffer_load_dwordx4 v52, s[12:15], s29 offen offset:2048 nt lds
  s_waitcnt vmcnt(10)
  s_cmp_gt_i32 s92, 0
  s_cbranch_scc1 L_d_90
  s_waitcnt vmcnt(6)
L_d_90:
  s_add_u32 m0, s34, 14208
  s_nop 0
  buffer_load_dwordx4 v52, s[12:15], s29 offen offset:128 nt lds
  s_waitcnt vmcnt(10)
  s_cmp_gt_i32 s92, 0
  s_cbranch_scc1 L_d_91
  s_waitcnt vmcnt(6)
L_d_91:
  s_add_u32 m0, s34, 13184
  s_nop 0
  buffer_load_dwordx4 v52, s[12:15], s29 offen offset:2176 nt lds
  s_waitcnt lgkmcnt(0)
  s_bcnt1_i32_b64 s80, s[80:81]
  s_bcnt1_i32_b64 s81, s[82:83]
  s_bcnt1_i32_b64 s82, s[84:85]
  s_bcnt1_i32_b64 s83, s[86:87]
  s_add_u32 s80, s80, s81
  s_add_u32 s82, s82, s83
  s_add_u32 s80, s80, s82
  s_cmp_ge_u32 s80, s68
  s_cselect_b32 s80, 6, 0
  s_sub_u32 s92, s92, 1
  s_cselect_b32 s92, s80, s92
  s_buffer_load_dwordx8 s[80:87], s[16:19], s69 offset:1280
  s_mov_b64 exec, 0x110
  s_cmp_eq_u32 s3, 1
  s_cselect_b32 s50, 0x800000, 0
  buffer_store_byte v2, v2, s[48:51], s93 offen offset:1152
  s_mov_b64 exec, -1
  s_waitcnt vmcnt(11)
  s_cmp_gt_i32 s92, 0
  s_cbranch_scc1 L_d_92
  s_waitcnt vmcnt(7)
L_d_92:
  s_add_u32 s29, s72, 0x4014000
  buffer_load_dwordx4 a[112:115], v52, s[12:15], s29 offen offset:0 nt
  s_waitcnt vmcnt(10)
  s_cmp_gt_i32 s92, 0
  s_cbranch_scc1 L_d_93
  s_waitcnt vmcnt(7)
L_d_93:
  buffer_load_dwordx4 a[116:119], v52, s[12:15], s29 offen offset:2048 nt
  s_waitcnt vmcnt(10)
  s_cmp_gt_i32 s92, 0
  s_cbranch_scc1 L_d_94
  s_waitcnt vmcnt(6)
L_d_94:
  buffer_load_dwordx4 a[120:123], v52, s[12:15], s29 offen offset:128 nt
  s_waitcnt vmcnt(10)
  s_cmp_gt_i32 s92, 0
  s_cbranch_scc1 L_d_95
  s_waitcnt vmcnt(6)
L_d_95:
  buffer_load_dwordx4 a[124:127], v52, s[12:15], s29 offen offset:2176 nt
  s_waitcnt lgkmcnt(0)
  s_bcnt1_i32_b64 s80, s[80:81]
  s_bcnt1_i32_b64 s81, s[82:83]
  s_bcnt1_i32_b64 s82, s[84:85]
  s_bcnt1_i32_b64 s83, s[86:87]
  s_add_u32 s80, s80, s81
  s_add_u32 s82, s82, s83
  s_add_u32 s80, s80, s82
  s_cmp_ge_u32 s80, s68
  s_cselect_b32 s80, 6, 0
  s_sub_u32 s92, s92, 1
  s_cselect_b32 s92, s80, s92
  s_buffer_load_dwordx8 s[80:87], s[16:19], s69 offset:1408
  s_mov_b64 exec, 0x110
  s_cmp_eq_u32 s3, 2
  s_cselect_b32 s50, 0x800000, 0
  buffer_store_byte v2, v2, s[48:51], s93 offen offset:1280
  s_mov_b64 exec, -1
  s_waitcnt vmcnt(11)
  s_cmp_gt_i32 s92, 0
  s_cbranch_scc1 L_d_96
  s_waitcnt vmcnt(7)
L_d_96:
  s_add_u32 s29, s73, 0x4018000
  s_add_u32 m0, s34, 20480
  s_nop 0
  buffer_load_dwordx4 v52, s[12:15], s29 offen offset:0 nt lds
  s_waitcnt vmcnt(10)
  s_cmp_gt_i32 s92, 0
  s_cbranch_scc1 L_d_97
  s_waitcnt vmcnt(7)
L_d_97:
  s_add_u32 m0, s34, 19456
  s_nop 0
  buffer_load_dwordx4 v52, s[12:15], s29 offen offset:2048 nt lds
  s_waitcnt vmcnt(10)
  s_cmp_gt_i32 s92, 0
  s_cbranch_scc1 L_d_98
  s_waitcnt vmcnt(6)
L_d_98:
  s_add_u32 m0, s34, 22400
  s_nop 0
  buffer_load_dwordx4 v52, s[12:15], s29 offen offset:128 nt lds
  s_waitcnt vmcnt(10)
  s_cmp_gt_i32 s92, 0
  s_cbranch_scc1 L_d_99
  s_waitcnt vmcnt(6)
L_d_99:
  s_add_u32 m0, s34, 21376
  s_nop 0
  buffer_load_dwordx4 v52, s[12:15], s29 offen offset:2176 nt lds
  s_waitcnt lgkmcnt(0)
  s_bcnt1_i32_b64 s80, s[80:81]
  s_bcnt1_i32_b64 s81, s[82:83]
  s_bcnt1_i32_b64 s82, s[84:85]
  s_bcnt1_i32_b64 s83, s[86:87]
  s_add_u32 s80, s80, s81
  s_add_u32 s82, s82, s83
  s_add_u32 s80, s80, s82
  s_cmp_ge_u32 s80, s68
  s_cselect_b32 s80, 6, 0
  s_sub_u32 s92, s92, 1
  s_cselect_b32 s92, s80, s92
  s_buffer_load_dwordx8 s[80:87], s[16:19], s69 offset:1536
  s_mov_b64 exec, 0x110
  s_cmp_eq_u32 s3, 3
  s_cselect_b32 s50, 0x800000, 0
  buffer_store_byte v2, v2, s[48:51], s93 offen offset:1408
  s_mov_b64 exec, -1
  s_waitcnt vmcnt(11)
  s_cmp_gt_i32 s92, 0
  s_cbranch_scc1 L_d_100
  s_waitcnt vmcnt(7)
L_d_100:
  s_add_u32 s29, s73, 0x401c000
  buffer_load_dwordx4 a[144:147], v52, s[12:15], s29 offen offset:0 nt
  s_waitcnt vmcnt(10)
  s_cmp_gt_i32 s92, 0
  s_cbranch_scc1 L_d_101
  s_waitcnt vmcnt(7)
L_d_101:
  buffer_load_dwordx4 a[148:151], v52, s[12:15], s29 offen offset:2048 nt
  s_waitcnt vmcnt(10)
  s_cmp_gt_i32 s92, 0
  s_cbranch_scc1 L_d_102
  s_waitcnt vmcnt(6)
L_d_102:
  buffer_load_dwordx4 a[152:155], v52, s[12:15], s29 offen offset:128 nt
  s_waitcnt vmcnt(10)
  s_cmp_gt_i32 s92, 0
  s_cbranch_scc1 L_d_103
  s_waitcnt vmcnt(6)
L_d_103:
  buffer_load_dwordx4 a[156:159], v52, s[12:15], s29 offen offset:2176 nt
  s_waitcnt lgkmcnt(0)
  s_bcnt1_i32_b64 s80, s[80:81]
  s_bcnt1_i32_b64 s81, s[82:83]
  s_bcnt1_i32_b64 s82, s[84:85]
  s_bcnt1_i32_b64 s83, s[86:87]
  s_add_u32 s80, s80, s81
  s_add_u32 s82, s82, s83
  s_add_u32 s80, s80, s82
  s_cmp_ge_u32 s80, s68
  s_cselect_b32 s80, 6, 0
  s_sub_u32 s92, s92, 1
  s_cselect_b32 s92, s80, s92
  s_buffer_load_dwordx8 s[80:87], s[16:19], s69 offset:1664
  s_mov_b64 exec, 0x110
  s_cmp_eq_u32 s3, 0
  s_cselect_b32 s50, 0x800000, 0
  buffer_store_byte v2, v2, s[48:51], s93 offen offset:1536
  s_mov_b64 exec, -1
  s_waitcnt vmcnt(11)
  s_cmp_gt_i32 s92, 0
  s_cbranch_scc1 L_d_104
  s_waitcnt vmcnt(7)
L_d_104:
  s_add_u32 s29, s74, 0x4020000
  s_add_u32 m0, s34, 28672
  s_nop 0
  buffer_load_dwordx4 v52, s[12:15], s29 offen offset:0 nt lds
  s_waitcnt vmcnt(10)
  s_cmp_gt_i32 s92, 0
  s_cbranch_scc1 L_d_105
  s_waitcnt vmcnt(7)
L_d_105:
  s_add_u32 m0, s34, 27648
  s_nop 0
  buffer_load_dwordx4 v52, s[12:15], s29 offen offset:2048 nt lds
  s_waitcnt vmcnt(10)
  s_cmp_gt_i32 s92, 0
  s_cbranch_scc1 L_d_106
  s_waitcnt vmcnt(6)
L_d_106:
  s_add_u32 m0, s34, 30592
  s_nop 0
  buffer_load_dwordx4 v52, s[12:15], s29 offen offset:128 nt lds
  s_waitcnt vmcnt(10)
  s_cmp_gt_i32 s92, 0
  s_cbranch_scc1 L_d_107
  s_waitcnt vmcnt(6)
L_d_107:
  s_add_u32 m0, s34, 29568
  s_nop 0
  buffer_load_dwordx4 v52, s[12:15], s29 offen offset:2176 nt lds
  s_waitcnt lgkmcnt(0)
  s_bcnt1_i32_b64 s80, s[80:81]
  s_bcnt1_i32_b64 s81, s[82:83]
  s_bcnt1_i32_b64 s82, s[84:85]
  s_bcnt1_i32_b64 s83, s[86:87]
  s_add_u32 s80, s80, s81
  s_add_u32 s82, s82, s83
  s_add_u32 s80, s80, s82
  s_cmp_ge_u32 s80, s68
  s_cselect_b32 s80, 6, 0
  s_sub_u32 s92, s92, 1
  s_cselect_b32 s92, s80, s92
  s_buffer_load_dwordx8 s[80:87], s[16:19], s69 offset:1792
  s_mov_b64 exec, 0x110
  s_cmp_eq_u32 s3, 1
  s_cselect_b32 s50, 0x800000, 0
  buffer_store_byte v2, v2, s[48:51], s93 offen offset:1664
  s_mov_b64 exec, -1
  s_waitcnt vmcnt(11)
  s_cmp_gt_i32 s92, 0
  s_cbranch_scc1 L_d_108
  s_waitcnt vmcnt(7)
L_d_108:
  s_add_u32 s29, s74, 0x4024000
  buffer_load_dwordx4 a[176:179], v52, s[12:15], s29 offen offset:0 nt
  s_waitcnt vmcnt(10)
  s_cmp_gt_i32 s92, 0
  s_cbranch_scc1 L_d_109
  s_waitcnt vmcnt(7)
L_d_109:
  buffer_load_dwordx4 a[180:183], v52, s[12:15], s29 offen offset:2048 nt
  s_waitcnt vmcnt(10)
  s_cmp_gt_i32 s92, 0
  s_cbranch_scc1 L_d_110
  s_waitcnt vmcnt(6)
L_d_110:
  buffer_load_dwordx4 a[184:187], v52, s[12:15], s29 offen offset:128 nt
  s_waitcnt vmcnt(10)
  s_cmp_gt_i32 s92, 0
  s_cbranch_scc1 L_d_111
  s_waitcnt vmcnt(6)
L_d_111:
  buffer_load_dwordx4 a[188:191], v52, s[12:15], s29 offen offset:2176 nt
  s_waitcnt lgkmcnt(0)
  s_bcnt1_i32_b64 s80, s[80:81]
  s_bcnt1_i32_b64 s81, s[82:83]
  s_bcnt1_i32_b64 s82, s[84:85]
  s_bcnt1_i32_b64 s83, s[86:87]
  s_add_u32 s80, s80, s81
  s_add_u32 s82, s82, s83
  s_add_u32 s80, s80, s82
  s_cmp_ge_u32 s80, s68
  s_cselect_b32 s80, 6, 0
  s_sub_u32 s92, s92, 1
  s_cselect_b32 s92, s80, s92
  s_buffer_load_dwordx8 s[80:87], s[16:19], s69 offset:1920
  s_mov_b64 exec, 0x110
  s_cmp_eq_u32 s3, 2
  s_cselect_b32 s50, 0x800000, 0
  buffer_store_byte v2, v2, s[48:51], s93 offen offset:1792
  s_mov_b64 exec, -1
  s_waitcnt vmcnt(11)
  s_cmp_gt_i32 s92, 0
  s_cbranch_scc1 L_d_112
  s_waitcnt vmcnt(7)
L_d_112:
  s_add_u32 s29, s75, 0x4028000
  buffer_load_dwordx4 a[208:211], v52, s[12:15], s29 offen offset:0 nt
  s_waitcnt vmcnt(10)
  s_cmp_gt_i32 s92, 0
  s_cbranch_scc1 L_d_113
  s_waitcnt vmcnt(7)
L_d_113:
  buffer_load_dwordx4 a[212:215], v52, s[12:15], s29 offen offset:2048 nt
  s_waitcnt vmcnt(10)
  s_cmp_gt_i32 s92, 0
  s_cbranch_scc1 L_d_114
  s_waitcnt vmcnt(6)
L_d_114:
  buffer_load_dwordx4 a[216:219], v52, s[12:15], s29 offen offset:128 nt
  s_waitcnt vmcnt(10)
  s_cmp_gt_i32 s92, 0
  s_cbranch_scc1 L_d_115
  s_waitcnt vmcnt(6)
L_d_115:
  buffer_load_dwordx4 a[220:223], v52, s[12:15], s29 offen offset:2176 nt
  s_waitcnt lgkmcnt(0)
  s_bcnt1_i32_b64 s80, s[80:81]
  s_bcnt1_i32_b64 s81, s[82:83]
  s_bcnt1_i32_b64 s82, s[84:85]
  s_bcnt1_i32_b64 s83, s[86:87]
  s_add_u32 s80, s80, s81
  s_add_u32 s82, s82, s83
  s_add_u32 s80, s80, s82
  s_cmp_ge_u32 s80, s68
  s_cselect_b32 s80, 6, 0
  s_sub_u32 s92, s92, 1
  s_cselect_b32 s92, s80, s92
  s_buffer_load_dwordx8 s[80:87], s[16:19], s69 offset:2048
  s_mov_b64 exec, 0x110
  s_cmp_eq_u32 s3, 3
  s_cselect_b32 s50, 0x800000, 0
  buffer_store_byte v2, v2, s[48:51], s93 offen offset:1920
  s_mov_b64 exec, -1
  s_waitcnt vmcnt(11)
  s_cmp_gt_i32 s92, 0
  s_cbranch_scc1 L_d_116
  s_waitcnt vmcnt(7)
L_d_116:
  s_add_u32 s29, s75, 0x402c000
  buffer_load_dwordx4 a[240:243], v52, s[12:15], s29 offen offset:0 nt
  s_waitcnt vmcnt(10)
  s_cmp_gt_i32 s92, 0
  s_cbranch_scc1 L_d_117
  s_waitcnt vmcnt(7)
L_d_117:
  buffer_load_dwordx4 a[244:247], v52, s[12:15], s29 offen offset:2048 nt
  s_waitcnt vmcnt(10)
  s_cmp_gt_i32 s92, 0
  s_cbranch_scc1 L_d_118
  s_waitcnt vmcnt(6)
L_d_118:
  buffer_load_dwordx4 a[248:251], v52, s[12:15], s29 offen offset:128 nt
  s_waitcnt vmcnt(10)
  s_cmp_gt_i32 s92, 0
  s_cbranch_scc1 L_d_119
  s_waitcnt vmcnt(6)
L_d_119:
  buffer_load_dwordx4 a[252:255], v52, s[12:15], s29 offen offset:2176 nt
  s_waitcnt lgkmcnt(0)
  s_mov_b32 s30, 2
  s_mov_b32 s27, 0x4000000
  s_branch L_C1
L_cl_66:
  s_add_u32 s29, s76, 0x4030000
  buffer_load_dwordx4 v[64:67], v1, s[8:11], s29 offen offset:0 nt
  buffer_load_dwordx4 v[68:71], v1, s[8:11], s29 offen offset:128 nt
  buffer_load_dwordx4 v[72:75], v1, s[8:11], s29 offen offset:1024 nt
  buffer_load_dwordx4 v[76:79], v1, s[8:11], s29 offen offset:1152 nt
  s_add_u32 s29, s76, 0x4030800
  buffer_load_dwordx4 v[96:99], v1, s[8:11], s29 offen offset:0 nt
  buffer_load_dwordx4 v[100:103], v1, s[8:11], s29 offen offset:128 nt
  buffer_load_dwordx4 v[104:107], v1, s[8:11], s29 offen offset:1024 nt
  buffer_load_dwordx4 v[108:111], v1, s[8:11], s29 offen offset:1152 nt
  s_cmp_eq_u32 s30, 1
  s_branch L_cl_66r
L_cl_67:
  s_add_u32 s29, s77, 0x4038000
  buffer_load_dwordx4 v[128:131], v1, s[8:11], s29 offen offset:0 nt
  buffer_load_dwordx4 v[132:135], v1, s[8:11], s29 offen offset:128 nt
  buffer_load_dwordx4 v[136:139], v1, s[8:11], s29 offen offset:1024 nt
  buffer_load_dwordx4 v[140:143], v1, s[8:11], s29 offen offset:1152 nt
  s_add_u32 s29, s77, 0x4038800
  buffer_load_dwordx4 v[160:163], v1, s[8:11], s29 offen offset:0 nt
  buffer_load_dwordx4 v[164:167], v1, s[8:11], s29 offen offset:128 nt
  buffer_load_dwordx4 v[168:171], v1, s[8:11], s29 offen offset:1024 nt
  buffer_load_dwordx4 v[172:175], v1, s[8:11], s29 offen offset:1152 nt
  s_cmp_eq_u32 s30, 1
  s_branch L_cl_67r
L_svc:
  s_mov_b32 s24, s64
  s_mov_b32 s25, s65
  s_mov_b32 s26, 0x800
  s_mov_b32 s27, 0x20000
  s_mov_b32 s28, s70
  s_mov_b32 s29, s71
  s_mov_b32 s30, 0x400000
  s_mov_b32 s31, 0x20000
  v_mov_b32 v55, v0
  v_bfe_u32 v32, v55, 4, 1
  v_lshlrev_b32 v53, 4, v32
  v_bfe_u32 v32, v55, 5, 1
  v_lshl_add_u32 v53, v32, 1, v53
  v_and_b32 v35, 15, v55
  v_lshlrev_b32 v35, 4, v35
  v_lshl_add_u32 v36, v53, 13, v35
  s_lshl_b32 s63, s3, 20
  s_lshl_b32 s4, s2, 8
  s_add_u32 s63, s63, s4
  s_lshl_b32 s62, s3, 8
  s_add_u32 s4, s63, 0
  buffer_load_dwordx4 a[32:35], v36, s[28:31], s4 offen nt
  s_add_u32 s4, s63, 8192
  buffer_load_dwordx4 a[36:39], v36, s[28:31], s4 offen nt
  s_add_u32 s4, s63, 65536
  buffer_load_dwordx4 a[40:43], v36, s[28:31], s4 offen nt
  s_add_u32 s4, s63, 73728
  buffer_load_dwordx4 a[44:47], v36, s[28:31], s4 offen nt
  v_bfe_u32 v32, v55, 0, 4
  v_lshlrev_b32 v54, 4, v32
  v_bfe_u32 v32, v55, 4, 2
  v_lshl_add_u32 v54, v32, 2, v54
  buffer_load_dword v236, v54, s[24:27], s62 offen offset:0
  buffer_load_dword v237, v54, s[24:27], s62 offen offset:1024
  s_add_u32 s4, s63, 32768
  buffer_load_dwordx4 a[48:51], v36, s[28:31], s4 offen nt
  s_add_u32 s4, s63, 40960
  buffer_load_dwordx4 a[52:55], v36, s[28:31], s4 offen nt
  s_add_u32 s4, s63, 98304
  buffer_load_dwordx4 a[56:59], v36, s[28:31], s4 offen nt
  s_add_u32 s4, s63, 106496
  buffer_load_dwordx4 a[60:63], v36, s[28:31], s4 offen nt
  s_add_u32 s4, s63, 262144
  buffer_load_dwordx4 a[64:67], v36, s[28:31], s4 offen nt
  s_add_u32 s4, s63, 270336
  buffer_load_dwordx4 a[68:71], v36, s[28:31], s4 offen nt
  s_add_u32 s4, s63, 327680
  buffer_load_dwordx4 a[72:75], v36, s[28:31], s4 offen nt
  s_add_u32 s4, s63, 335872
  buffer_load_dwordx4 a[76:79], v36, s[28:31], s4 offen nt
  s_add_u32 s4, s63, 294912
  buffer_load_dwordx4 a[80:83], v36, s[28:31], s4 offen nt
  s_add_u32 s4, s63, 303104
  buffer_load_dwordx4 a[84:87], v36, s[28:31], s4 offen nt
  s_add_u32 s4, s63, 360448
  buffer_load_dwordx4 a[88:91], v36, s[28:31], s4 offen nt
  s_add_u32 s4, s63, 368640
  buffer_load_dwordx4 a[92:95], v36, s[28:31], s4 offen nt
  s_add_u32 s4, s63, 524288
  buffer_load_dwordx4 a[96:99], v36, s[28:31], s4 offen nt
  s_add_u32 s4, s63, 532480
  buffer_load_dwordx4 a[100:103], v36, s[28:31], s4 offen nt
  s_add_u32 s4, s63, 589824
  buffer_load_dwordx4 a[104:107], v36, s[28:31], s4 offen nt
  s_add_u32 s4, s63, 598016
  buffer_load_dwordx4 a[108:111], v36, s[28:31], s4 offen nt
  s_add_u32 s4, s63, 557056
  buffer_load_dwordx4 a[112:115], v36, s[28:31], s4 offen nt
  s_add_u32 s4, s63, 565248
  buffer_load_dwordx4 a[116:119], v36, s[28:31], s4 offen nt
  s_add_u32 s4, s63, 622592
  buffer_load_dwordx4 a[120:123], v36, s[28:31], s4 offen nt
  s_add_u32 s4, s63, 630784
  buffer_load_dwordx4 a[124:127], v36, s[28:31], s4 offen nt
  s_add_u32 s4, s63, 786432
  buffer_load_dwordx4 a[128:131], v36, s[28:31], s4 offen nt
  s_add_u32 s4, s63, 794624
  buffer_load_dwordx4 a[132:135], v36, s[28:31], s4 offen nt
  s_add_u32 s4, s63, 851968
  buffer_load_dwordx4 a[136:139], v36, s[28:31], s4 offen nt
  s_add_u32 s4, s63, 860160
  buffer_load_dwordx4 a[140:143], v36, s[28:31], s4 offen nt
  s_add_u32 s4, s63, 819200
  buffer_load_dwordx4 a[144:147], v36, s[28:31], s4 offen nt
  s_add_u32 s4, s63, 827392
  buffer_load_dwordx4 a[148:151], v36, s[28:31], s4 offen nt
  s_add_u32 s4, s63, 884736
  buffer_load_dwordx4 a[152:155], v36, s[28:31], s4 offen nt
  s_add_u32 s4, s63, 892928
  buffer_load_dwordx4 a[156:159], v36, s[28:31], s4 offen nt
  s_mov_b32 s12, s68
  s_mov_b32 s13, s69
  s_mov_b32 s14, 0x8000000
  s_mov_b32 s15, 0x20000
  s_mov_b32 s16, s86
  s_mov_b32 s17, s87
  s_mov_b32 s18, 0x800000
  s_mov_b32 s19, 0x20000
  s_mov_b32 s20, s84
  s_mov_b32 s21, s85
  s_mov_b32 s22, 0x100
  s_mov_b32 s23, 0x20000
  s_mov_b32 s52, 0xf000f
  s_mov_b32 s53, 0xf000f
  s_mov_b32 s54, 0xf000f0
  s_mov_b32 s55, 0xf000f0
  s_mov_b32 s56, 0xf000f00
  s_mov_b32 s57, 0xf000f00
  s_mov_b32 s58, 0xf000f000
  s_mov_b32 s59, 0xf000f000
  s_mov_b32 s60, 0x3e0293ee
  s_mov_b32 s96, 0xaaaaaaaa
  s_mov_b32 s97, 0xaaaaaaaa
  s_mov_b32 s32, s72
  s_mov_b32 s33, s73
  s_mov_b32 s34, 0x400000
  s_mov_b32 s35, 0x20000
  s_mov_b32 s36, s76
  s_mov_b32 s37, s77
  s_mov_b32 s38, 0x1c0000
  s_mov_b32 s39, 0x20000
  s_mov_b32 s40, s78
  s_mov_b32 s41, s79
  s_mov_b32 s42, 0x1c0000
  s_mov_b32 s43, 0x20000
  s_mov_b32 s44, s80
  s_mov_b32 s45, s81
  s_mov_b32 s46, 0x1c0000
  s_mov_b32 s47, 0x20000
  s_mov_b32 s48, s82
  s_mov_b32 s49, s83
  s_mov_b32 s50, 0x800
  s_mov_b32 s51, 0x20000
  s_cmp_lt_u32 s2, 28
  s_cselect_b32 s38, 0x1c0000, 0
  s_cselect_b32 s42, 0x1c0000, 0
  v_bfe_u32 v32, v55, 3, 1
  v_lshlrev_b32 v10, 9, v32
  v_bfe_u32 v32, v55, 4, 2
  v_lshl_add_u32 v10, v32, 7, v10
  v_bfe_u32 v32, v55, 0, 1
  v_lshl_add_u32 v10, v32, 6, v10
  v_bfe_u32 v32, v55, 1, 1
  v_lshl_add_u32 v10, v32, 5, v10
  v_bfe_u32 v32, v55, 2, 1
  v_lshl_add_u32 v10, v32, 4, v10
  v_add_u32 v10, 8192, v10
  v_mov_b32 v48, -1
  v_mov_b32 v49, -1
  v_mov_b32 v50, -1
  v_mov_b32 v51, -1
  s_lshl_b32 s7, s2, 8
  s_add_u32 s7, s7, 0x700000
  s_lshl_b32 s4, s3, 13
  s_add_u32 s4, s4, s7
  v_lshlrev_b32 v37, 2, v55
  buffer_store_dword v48, v37, s[16:19], s4 offen sc1
  s_add_u32 s4, s4, 0x10000
  buffer_store_dword v48, v37, s[16:19], s4 offen
  s_lshl_b32 s5, s2, 14
  s_add_u32 s5, s5, 0x100000
  s_lshl_b32 s4, s3, 11
  s_add_u32 s4, s4, s5
  buffer_store_dwordx4 v[48:51], v2, s[16:19], s4 offen offset:0 sc1
  buffer_store_dwordx4 v[48:51], v2, s[16:19], s4 offen offset:1024 sc1
  v_bfe_u32 v32, v55, 0, 4
  v_lshlrev_b32 v38, 4, v32
  v_bfe_u32 v32, v55, 4, 2
  v_lshl_add_u32 v38, v32, 26, v38
  s_lshl_b32 s4, s3, 8
  s_add_u32 s4, s4, s5
  s_add_u32 s4, s4, 8192
  buffer_store_dwordx4 v[48:51], v38, s[16:19], s4 offen sc1
  v_and_b32 v32, 15, v55
  v_lshrrev_b32 v47, 1, v55
  v_lshl_add_u32 v47, v32, 26, v47
  s_mul_i32 s4, s3, -224
  s_add_u32 s4, s4, 1920
  v_add_u32 v47, s4, v47
  s_add_u32 s4, s62, s5
  s_add_u32 s61, s4, 0x81c00
  buffer_store_dword v48, v37, s[16:19], s61 offen sc1
  buffer_store_dwordx2 v[48:49], v47, s[16:19], s61 offen sc1
  s_add_u32 s61, s4, 0x101c00
  buffer_store_dword v48, v37, s[16:19], s61 offen sc1
  buffer_store_dwordx2 v[48:49], v47, s[16:19], s61 offen sc1
  s_add_u32 s61, s4, 0x181c00
  buffer_store_dword v48, v37, s[16:19], s61 offen sc1
  buffer_store_dwordx2 v[48:49], v47, s[16:19], s61 offen sc1
  s_and_b32 s5, s2, 7
  s_lshl3_add_u32 s5, s3, s5
  s_lshl_b32 s5, s5, 14
  s_add_u32 s5, s5, 0x100000
  s_lshl_b32 s6, s2, 10
  s_add_u32 s6, s6, 0x600000
  s_and_b32 s4, s2, 24
  s_lshl_b32 s4, s4, 10
  s_add_u32 s6, s6, s4
  s_lshl_b32 s4, s3, 17
  s_add_u32 s4, s4, s6
  buffer_store_dwordx4 v[48:51], v2, s[16:19], s4 offen sc1
  s_add_u32 s4, s4, 8192
  buffer_store_dwordx4 v[48:51], v2, s[16:19], s4 offen sc1
  s_add_u32 s4, s4, 57344
  buffer_store_dwordx4 v[48:51], v2, s[16:19], s4 offen sc1
  s_add_u32 s4, s4, 8192
  buffer_store_dwordx4 v[48:51], v2, s[16:19], s4 offen sc1
  v_bfe_u32 v32, v55, 4, 2
  v_lshl_add_u32 v1, v32, 10, s62
  v_bfe_u32 v32, v55, 0, 4
  v_lshl_add_u32 v1, v32, 4, v1
  v_bfe_u32 v32, v55, 0, 3
  v_lshlrev_b32 v4, 4, v32
  v_bfe_u32 v32, v55, 4, 1
  v_lshl_add_u32 v4, v32, 8, v4
  v_bfe_u32 v32, v55, 3, 1
  v_lshl_add_u32 v4, v32, 9, v4
  v_bfe_u32 v32, v55, 5, 1
  v_lshl_add_u32 v4, v32, 10, v4
  v_bfe_u32 v32, v55, 0, 1
  v_lshlrev_b32 v52, 4, v32
  v_bfe_u32 v32, v55, 4, 2
  v_lshl_add_u32 v52, v32, 5, v52
  v_bfe_u32 v32, v55, 1, 2
  v_lshl_add_u32 v52, v32, 8, v52
  v_bfe_u32 v32, v55, 3, 1
  v_lshl_add_u32 v52, v32, 12, v52
  v_and_b32 v32, 1, v55
  v_mul_u32_u24 v7, 0x5555, v32
  v_add_u32 v7, 0x8888, v7
  s_mov_b32 s78, 0x3f803f80
  s_mov_b32 s79, 0x37a7c5ac
  v_bfe_u32 v32, v55, 1, 2
  v_mul_u32_u24 v32, 0x5555, v32
  v_lshl_add_u32 v7, v32, 16, v7
  v_bfe_u32 v32, v55, 0, 4
  v_lshl_add_u32 v3, v32, 4, s62
  v_bfe_u32 v32, v55, 4, 1
  v_lshl_add_u32 v3, v32, 13, v3
  v_bfe_u32 v32, v55, 5, 1
  v_lshl_add_u32 v3, v32, 28, v3
  s_lshr_b32 s4, s3, 1
  s_lshl_b32 s4, s4, 7
  s_and_b32 s61, s3, 1
  s_add_u32 s4, s4, s61
  s_lshl_b32 s4, s4, 3
  v_bfe_u32 v32, v55, 0, 5
  v_lshl_add_u32 v5, v32, 4, s4
  v_bfe_u32 v32, v55, 5, 1
  v_lshl_add_u32 v5, v32, 2, v5
  s_add_u32 s4, s4, 2048
  v_bfe_u32 v32, v55, 2, 2
  v_lshl_add_u32 v6, v32, 8, s4
  v_bfe_u32 v32, v55, 0, 1
  v_lshl_add_u32 v6, v32, 6, v6
  v_bfe_u32 v32, v55, 1, 1
  v_lshl_add_u32 v6, v32, 5, v6
  s_movk_i32 s4, 3584
  v_lshrrev_b32 v35, 1, v35
  v_mul_lo_u32 v28, s4, v53
  v_add_u32 v28, v28, v35
  v_bfe_u32 v32, v55, 0, 4
  v_lshl_add_u32 v29, v32, 4, s62
  v_bfe_u32 v32, v55, 4, 1
  v_lshl_add_u32 v29, v32, 14, v29
  v_bfe_u32 v32, v55, 5, 1
  v_lshl_add_u32 v29, v32, 10, v29
  s_lshr_b32 s4, s2, 3
  s_lshl_b32 s4, s4, 8
  v_bfe_u32 v32, v55, 0, 4
  v_lshl_add_u32 v30, v32, 4, s4
  v_bfe_u32 v32, v55, 5, 1
  v_lshl_add_u32 v30, v32, 13, v30
  v_bfe_u32 v32, v55, 4, 1
  v_lshl_add_u32 v30, v32, 10, v30
  v_mov_b64 v[20:21], 0
  v_mov_b64 v[22:23], 0
  v_mov_b64 v[24:25], 0
  v_mov_b64 v[26:27], 0
  s_lshl_b32 s63, s2, 21
  s_lshl_b32 s4, s3, 13
  s_add_u32 s63, s63, s4
  s_add_u32 s63, s63, 2064384
  s_lshl_b32 s4, s3, 14
  s_add_u32 s88, s4, 16384
  s_add_u32 s4, s63, 0x0
  s_add_u32 m0, s88, 0
  s_nop 0
  buffer_load_dwordx4 v52, s[8:11], s4 offen offset:0 nt lds
  s_add_u32 m0, s88, 896
  s_nop 0
  buffer_load_dwordx4 v52, s[8:11], s4 offen offset:128 nt lds
  s_add_u32 m0, s88, 1024
  s_nop 0
  buffer_load_dwordx4 v52, s[8:11], s4 offen offset:1024 nt lds
  s_add_u32 m0, s88, 1920
  s_nop 0
  buffer_load_dwordx4 v52, s[8:11], s4 offen offset:1152 nt lds
  s_add_u32 s4, s63, 0x800
  s_add_u32 m0, s88, 8192
  s_nop 0
  buffer_load_dwordx4 v52, s[8:11], s4 offen offset:0 nt lds
  s_add_u32 m0, s88, 9088
  s_nop 0
  buffer_load_dwordx4 v52, s[8:11], s4 offen offset:128 nt lds
  s_add_u32 m0, s88, 9216
  s_nop 0
  buffer_load_dwordx4 v52, s[8:11], s4 offen offset:1024 nt lds
  s_add_u32 m0, s88, 10112
  s_nop 0
  buffer_load_dwordx4 v52, s[8:11], s4 offen offset:1152 nt lds
  s_add_u32 s4, s63, 0x0
  s_add_u32 m0, s88, 4096
  s_nop 0
  buffer_load_dwordx4 v4, s[12:15], s4 offen offset:0 nt lds
  s_add_u32 m0, s88, 3072
  s_nop 0
  buffer_load_dwordx4 v4, s[12:15], s4 offen offset:2048 nt lds
  s_add_u32 m0, s88, 6016
  s_nop 0
  buffer_load_dwordx4 v4, s[12:15], s4 offen offset:128 nt lds
  s_add_u32 m0, s88, 4992
  s_nop 0
  buffer_load_dwordx4 v4, s[12:15], s4 offen offset:2176 nt lds
  s_add_u32 s4, s63, 0x1000
  s_add_u32 m0, s88, 12288
  s_nop 0
  buffer_load_dwordx4 v4, s[12:15], s4 offen offset:0 nt lds
  s_add_u32 m0, s88, 11264
  s_nop 0
  buffer_load_dwordx4 v4, s[12:15], s4 offen offset:2048 nt lds
  s_waitcnt vmcnt(62)
  s_add_u32 m0, s88, 14208
  s_nop 0
  buffer_load_dwordx4 v4, s[12:15], s4 offen offset:128 nt lds
  s_waitcnt vmcnt(62)
  s_add_u32 m0, s88, 13184
  s_nop 0
  buffer_load_dwordx4 v4, s[12:15], s4 offen offset:2176 nt lds
  s_lshl_b32 s92, s3, 12
  s_add_u32 s92, s92, 147456
  s_waitcnt vmcnt(31)
  v_accvgpr_mov_b32 a0, a32
  v_accvgpr_mov_b32 a1, a36
  v_accvgpr_mov_b32 a2, a40
  v_accvgpr_mov_b32 a3, a44
  v_accvgpr_mov_b32 a4, a48
  v_accvgpr_mov_b32 a5, a52
  v_accvgpr_mov_b32 a6, a56
  v_accvgpr_mov_b32 a7, a60
  v_accvgpr_mov_b32 a8, a33
  v_accvgpr_mov_b32 a9, a37
  v_accvgpr_mov_b32 a10, a41
  v_accvgpr_mov_b32 a11, a45
  v_accvgpr_mov_b32 a12, a49
  v_accvgpr_mov_b32 a13, a53
  v_accvgpr_mov_b32 a14, a57
  v_accvgpr_mov_b32 a15, a61
  v_accvgpr_mov_b32 a16, a34
  v_accvgpr_mov_b32 a17, a38
  v_accvgpr_mov_b32 a18, a42
  v_accvgpr_mov_b32 a19, a46
  v_accvgpr_mov_b32 a20, a50
  v_accvgpr_mov_b32 a21, a54
  v_accvgpr_mov_b32 a22, a58
  v_accvgpr_mov_b32 a23, a62
  v_accvgpr_mov_b32 a24, a35
  v_accvgpr_mov_b32 a25, a39
  v_accvgpr_mov_b32 a26, a43
  v_accvgpr_mov_b32 a27, a47
  v_accvgpr_mov_b32 a28, a51
  v_accvgpr_mov_b32 a29, a55
  v_accvgpr_mov_b32 a30, a59
  v_accvgpr_mov_b32 a31, a63
  v_accvgpr_mov_b32 a32, a64
  v_accvgpr_mov_b32 a33, a68
  v_accvgpr_mov_b32 a34, a72
  v_accvgpr_mov_b32 a35, a76
  v_accvgpr_mov_b32 a36, a80
  v_accvgpr_mov_b32 a37, a84
  v_accvgpr_mov_b32 a38, a88
  v_accvgpr_mov_b32 a39, a92
  v_accvgpr_mov_b32 a40, a65
  v_accvgpr_mov_b32 a41, a69
  v_accvgpr_mov_b32 a42, a73
  v_accvgpr_mov_b32 a43, a77
  v_accvgpr_mov_b32 a44, a81
  v_accvgpr_mov_b32 a45, a85
  v_accvgpr_mov_b32 a46, a89
  v_accvgpr_mov_b32 a47, a93
  v_accvgpr_mov_b32 a48, a66
  v_accvgpr_mov_b32 a49, a70
  v_accvgpr_mov_b32 a50, a74
  v_accvgpr_mov_b32 a51, a78
  v_accvgpr_mov_b32 a52, a82
  v_accvgpr_mov_b32 a53, a86
  v_accvgpr_mov_b32 a54, a90
  v_accvgpr_mov_b32 a55, a94
  v_accvgpr_mov_b32 a56, a67
  v_accvgpr_mov_b32 a57, a71
  v_accvgpr_mov_b32 a58, a75
  v_accvgpr_mov_b32 a59, a79
  v_accvgpr_mov_b32 a60, a83
  v_accvgpr_mov_b32 a61, a87
  v_accvgpr_mov_b32 a62, a91
  v_accvgpr_mov_b32 a63, a95
  v_accvgpr_mov_b32 a64, a96
  v_accvgpr_mov_b32 a65, a100
  v_accvgpr_mov_b32 a66, a104
  v_accvgpr_mov_b32 a67, a108
  v_accvgpr_mov_b32 a68, a112
  v_accvgpr_mov_b32 a69, a116
  v_accvgpr_mov_b32 a70, a120
  v_accvgpr_mov_b32 a71, a124
  v_accvgpr_mov_b32 a72, a97
  v_accvgpr_mov_b32 a73, a101
  v_accvgpr_mov_b32 a74, a105
  v_accvgpr_mov_b32 a75, a109
  v_accvgpr_mov_b32 a76, a113
  v_accvgpr_mov_b32 a77, a117
  v_accvgpr_mov_b32 a78, a121
  v_accvgpr_mov_b32 a79, a125
  v_accvgpr_mov_b32 a80, a98
  v_accvgpr_mov_b32 a81, a102
  v_accvgpr_mov_b32 a82, a106
  v_accvgpr_mov_b32 a83, a110
  v_accvgpr_mov_b32 a84, a114
  v_accvgpr_mov_b32 a85, a118
  v_accvgpr_mov_b32 a86, a122
  v_accvgpr_mov_b32 a87, a126
  v_accvgpr_mov_b32 a88, a99
  v_accvgpr_mov_b32 a89, a103
  v_accvgpr_mov_b32 a90, a107
  v_accvgpr_mov_b32 a91, a111
  v_accvgpr_mov_b32 a92, a115
  v_accvgpr_mov_b32 a93, a119
  v_accvgpr_mov_b32 a94, a123
  v_accvgpr_mov_b32 a95, a127
  v_accvgpr_mov_b32 a96, a128
  v_accvgpr_mov_b32 a97, a132
  v_accvgpr_mov_b32 a98, a136
  v_accvgpr_mov_b32 a99, a140
  v_accvgpr_mov_b32 a100, a144
  v_accvgpr_mov_b32 a101, a148
  v_accvgpr_mov_b32 a102, a152
  v_accvgpr_mov_b32 a103, a156
  v_accvgpr_mov_b32 a104, a129
  v_accvgpr_mov_b32 a105, a133
  v_accvgpr_mov_b32 a106, a137
  v_accvgpr_mov_b32 a107, a141
  v_accvgpr_mov_b32 a108, a145
  v_accvgpr_mov_b32 a109, a149
  v_accvgpr_mov_b32 a110, a153
  v_accvgpr_mov_b32 a111, a157
  v_accvgpr_mov_b32 a112, a130
  v_accvgpr_mov_b32 a113, a134
  v_accvgpr_mov_b32 a114, a138
  v_accvgpr_mov_b32 a115, a142
  v_accvgpr_mov_b32 a116, a146
  v_accvgpr_mov_b32 a117, a150
  v_accvgpr_mov_b32 a118, a154
  v_accvgpr_mov_b32 a119, a158
  v_accvgpr_mov_b32 a120, a131
  v_accvgpr_mov_b32 a121, a135
  v_accvgpr_mov_b32 a122, a139
  v_accvgpr_mov_b32 a123, a143
  v_accvgpr_mov_b32 a124, a147
  v_accvgpr_mov_b32 a125, a151
  v_accvgpr_mov_b32 a126, a155
  v_accvgpr_mov_b32 a127, a159
  v_mov_b32 v32, s78
  v_mov_b32 v33, s78
  v_mov_b32 v34, s78
  v_mov_b32 v35, s78
  v_mov_b64 v[240:241], 0
  v_mov_b64 v[244:245], 0
  v_mov_b64 v[248:249], 0
  v_mov_b64 v[252:253], 0
  v_smfmac_f32_16x16x64_bf16 v[240:243], v[32:35], a[0:7], v7
  v_smfmac_f32_16x16x64_bf16 v[244:247], v[32:35], a[8:15], v7
  v_smfmac_f32_16x16x64_bf16 v[248:251], v[32:35], a[16:23], v7
  v_smfmac_f32_16x16x64_bf16 v[252:255], v[32:35], a[24:31], v7
  v_smfmac_f32_16x16x64_bf16 v[240:243], v[32:35], a[32:39], v7
  v_smfmac_f32_16x16x64_bf16 v[244:247], v[32:35], a[40:47], v7
  v_smfmac_f32_16x16x64_bf16 v[248:251], v[32:35], a[48:55], v7
  v_smfmac_f32_16x16x64_bf16 v[252:255], v[32:35], a[56:63], v7
  v_smfmac_f32_16x16x64_bf16 v[240:243], v[32:35], a[64:71], v7
  v_smfmac_f32_16x16x64_bf16 v[244:247], v[32:35], a[72:79], v7
  v_smfmac_f32_16x16x64_bf16 v[248:251], v[32:35], a[80:87], v7
  v_smfmac_f32_16x16x64_bf16 v[252:255], v[32:35], a[88:95], v7
  v_smfmac_f32_16x16x64_bf16 v[240:243], v[32:35], a[96:103], v7
  v_smfmac_f32_16x16x64_bf16 v[244:247], v[32:35], a[104:111], v7
  v_smfmac_f32_16x16x64_bf16 v[248:251], v[32:35], a[112:119], v7
  v_smfmac_f32_16x16x64_bf16 v[252:255], v[32:35], a[120:127], v7
  v_mov_b32 v53, 0
  s_mov_b64 exec, 0xffff
  s_nop 3
  ds_write2_b64 v6, v[240:241], v[244:245] offset0:0 offset1:16
  s_nop 0
  ds_write2_b64 v6, v[248:249], v[252:253] offset0:2 offset1:18
  s_mov_b64 exec, -1
  s_waitcnt lgkmcnt(0)
  s_barrier
  ds_read_b128 v[248:251], v2 offset:2048
  ds_read_b128 v[252:255], v2 offset:3072
  s_waitcnt lgkmcnt(0)
  v_pk_add_f32 v[248:249], v[248:249], v[250:251]
  v_pk_add_f32 v[252:253], v[252:253], v[254:255]
  v_pk_add_f32 v[248:249], v[248:249], v[252:253]
  v_mov_b32 v14, v248
  v_mov_b32 v15, v249
  s_waitcnt vmcnt(16)
  s_barrier
  s_cmp_lg_u32 s3, 0
  s_cbranch_scc1 L_noflag
  s_getreg_b32 s61, hwreg(HW_REG_XCC_ID, 0, 4)
  s_add_u32 s61, s61, 1
  v_mov_b32 v32, s61
  s_and_b32 s61, s2, 7
  s_lshr_b32 s4, s2, 3
  s_lshl2_add_u32 s61, s61, s4
  s_lshl_b32 s61, s61, 2
  s_mov_b64 exec, 1
  buffer_store_dword v32, off, s[20:23], s61 sc1
  s_mov_b64 exec, -1
L_noflag:
  s_and_b32 s87, s2, 7
  s_lshl3_add_u32 s87, s3, s87
  s_lshl_b32 s87, s87, 17
  s_mul_i32 s86, s3, 458752
  s_lshl_b32 s4, s2, 7
  s_add_u32 s86, s86, s4
  s_lshl_b32 s85, s2, 16
  s_add_u32 s4, s87, 0
  s_waitcnt vmcnt(9)
  buffer_load_dwordx4 a[160:163], v30, s[32:35], s4 offen offset:0 nt
  s_waitcnt vmcnt(9)
  buffer_load_dwordx4 a[164:167], v30, s[32:35], s4 offen offset:2048 nt
  s_add_u32 s4, s87, 32768
  s_waitcnt vmcnt(9)
  buffer_load_dwordx4 a[168:171], v30, s[32:35], s4 offen offset:0 nt
  s_waitcnt vmcnt(9)
  buffer_load_dwordx4 a[172:175], v30, s[32:35], s4 offen offset:2048 nt
  s_add_u32 s4, s87, 16384
  s_waitcnt vmcnt(9)
  buffer_load_dwordx4 a[176:179], v30, s[32:35], s4 offen offset:0 nt
  s_waitcnt vmcnt(9)
  buffer_load_dwordx4 a[180:183], v30, s[32:35], s4 offen offset:2048 nt
  s_add_u32 s4, s87, 49152
  s_waitcnt vmcnt(9)
  buffer_load_dwordx4 a[184:187], v30, s[32:35], s4 offen offset:0 nt
  s_waitcnt vmcnt(9)
  buffer_load_dwordx4 a[188:191], v30, s[32:35], s4 offen offset:2048 nt
  v_mov_b64 v[248:249], -1
  v_mov_b64 v[250:251], -1
  v_lshl_add_u32 v252, s62, 2, v2
  v_lshrrev_b32 v253, 1, v252
  ds_write_b128 v252, v[248:251] offset:0
  ds_write_b128 v252, v[248:251] offset:4096
  ds_write_b64 v253, v[248:249] offset:8192
  s_waitcnt lgkmcnt(0)
  s_barrier
  s_mov_b32 s61, 0
  v_mov_b32 v50, v237
  v_mov_b64 v[240:241], 0
  v_mov_b64 v[244:245], 0
  v_mov_b64 v[248:249], 0
  v_mov_b64 v[252:253], 0
  v_cmp_ne_u32 vcc, v2, v2
  s_mov_b32 s89, 2
  s_mov_b32 s98, 0
  s_branch L_QG
L_qret0:
  s_barrier
  s_add_u32 s4, s87, 65536
  s_waitcnt vmcnt(9)
  buffer_load_dwordx4 a[192:195], v30, s[32:35], s4 offen offset:0 nt
  s_waitcnt vmcnt(9)
  buffer_load_dwordx4 a[196:199], v30, s[32:35], s4 offen offset:2048 nt
  s_add_u32 s4, s87, 98304
  s_waitcnt vmcnt(9)
  buffer_load_dwordx4 a[200:203], v30, s[32:35], s4 offen offset:0 nt
  s_waitcnt vmcnt(9)
  buffer_load_dwordx4 a[204:207], v30, s[32:35], s4 offen offset:2048 nt
  s_add_u32 s4, s87, 81920
  s_waitcnt vmcnt(9)
  buffer_load_dwordx4 a[208:211], v30, s[32:35], s4 offen offset:0 nt
  s_waitcnt vmcnt(9)
  buffer_load_dwordx4 a[212:215], v30, s[32:35], s4 offen offset:2048 nt
  s_add_u32 s4, s87, 114688
  s_waitcnt vmcnt(9)
  buffer_load_dwordx4 a[216:219], v30, s[32:35], s4 offen offset:0 nt
  s_waitcnt vmcnt(9)
  buffer_load_dwordx4 a[220:223], v30, s[32:35], s4 offen offset:2048 nt
  v_mov_b64 v[248:249], -1
  v_mov_b64 v[250:251], -1
  v_lshl_add_u32 v252, s62, 2, v2
  v_lshrrev_b32 v253, 1, v252
  ds_write_b128 v252, v[248:251] offset:0
  ds_write_b128 v252, v[248:251] offset:4096
  ds_write_b64 v253, v[248:249] offset:8192
  s_waitcnt lgkmcnt(0)
  s_barrier
  s_mov_b32 s61, 0
  v_mov_b32 v50, v236
  v_mov_b64 v[240:241], 0
  v_mov_b64 v[244:245], 0
  v_mov_b64 v[248:249], 0
  v_mov_b64 v[252:253], 0
  v_cmp_ne_u32 vcc, v2, v2
  s_mov_b32 s89, 0
  s_mov_b32 s98, 1
  s_branch L_QG
L_qret1:
  s_add_u32 s4, s87, 4096
  s_waitcnt vmcnt(9)
  buffer_load_dwordx4 a[224:227], v30, s[32:35], s4 offen offset:0 nt
  s_waitcnt vmcnt(9)
  buffer_load_dwordx4 a[228:231], v30, s[32:35], s4 offen offset:2048 nt
  s_add_u32 s4, s87, 36864
  s_waitcnt vmcnt(9)
  buffer_load_dwordx4 a[232:235], v30, s[32:35], s4 offen offset:0 nt
  s_waitcnt vmcnt(9)
  buffer_load_dwordx4 a[236:239], v30, s[32:35], s4 offen offset:2048 nt
  s_add_u32 s4, s87, 20480
  s_waitcnt vmcnt(9)
  buffer_load_dwordx4 a[240:243], v30, s[32:35], s4 offen offset:0 nt
  s_waitcnt vmcnt(9)
  buffer_load_dwordx4 a[244:247], v30, s[32:35], s4 offen offset:2048 nt
  s_add_u32 s4, s87, 53248
  s_waitcnt vmcnt(9)
  buffer_load_dwordx4 a[248:251], v30, s[32:35], s4 offen offset:0 nt
  s_waitcnt vmcnt(9)
  buffer_load_dwordx4 a[252:255], v30, s[32:35], s4 offen offset:2048 nt
  s_add_u32 s4, s87, 69632
  s_waitcnt vmcnt(9)
  buffer_load_dwordx4 v[64:67], v30, s[32:35], s4 offen offset:0 nt
  s_waitcnt vmcnt(9)
  buffer_load_dwordx4 v[68:71], v30, s[32:35], s4 offen offset:2048 nt
  s_add_u32 s4, s87, 102400
  s_waitcnt vmcnt(9)
  buffer_load_dwordx4 v[72:75], v30, s[32:35], s4 offen offset:0 nt
  s_waitcnt vmcnt(9)
  buffer_load_dwordx4 v[76:79], v30, s[32:35], s4 offen offset:2048 nt
  s_add_u32 s4, s87, 86016
  s_waitcnt vmcnt(9)
  buffer_load_dwordx4 v[80:83], v30, s[32:35], s4 offen offset:0 nt
  s_waitcnt vmcnt(9)
  buffer_load_dwordx4 v[84:87], v30, s[32:35], s4 offen offset:2048 nt
  s_add_u32 s4, s87, 118784
  s_waitcnt vmcnt(9)
  buffer_load_dwordx4 v[88:91], v30, s[32:35], s4 offen offset:0 nt
  s_waitcnt vmcnt(9)
  buffer_load_dwordx4 v[92:95], v30, s[32:35], s4 offen offset:2048 nt
  s_add_u32 s4, s86, 0
  buffer_load_dwordx2 v[96:97], v28, s[36:39], s4 offen offset:0 nt
  buffer_load_dwordx2 v[98:99], v28, s[40:43], s4 offen offset:0 nt
  buffer_load_dwordx2 v[100:101], v28, s[36:39], s4 offen offset:3584 nt
  buffer_load_dwordx2 v[102:103], v28, s[40:43], s4 offen offset:3584 nt
  s_add_u32 s4, s86, 28672
  buffer_load_dwordx2 v[104:105], v28, s[36:39], s4 offen offset:0 nt
  buffer_load_dwordx2 v[106:107], v28, s[40:43], s4 offen offset:0 nt
  buffer_load_dwordx2 v[108:109], v28, s[36:39], s4 offen offset:3584 nt
  buffer_load_dwordx2 v[110:111], v28, s[40:43], s4 offen offset:3584 nt
  s_add_u32 s4, s86, 14336
  buffer_load_dwordx2 v[112:113], v28, s[36:39], s4 offen offset:0 nt
  buffer_load_dwordx2 v[114:115], v28, s[40:43], s4 offen offset:0 nt
  s_waitcnt vmcnt(19)
  buffer_load_dwordx2 v[116:117], v28, s[36:39], s4 offen offset:3584 nt
  s_waitcnt vmcnt(19)
  buffer_load_dwordx2 v[118:119], v28, s[40:43], s4 offen offset:3584 nt
  s_add_u32 s4, s86, 43008
  s_waitcnt vmcnt(19)
  buffer_load_dwordx2 v[120:121], v28, s[36:39], s4 offen offset:0 nt
  s_waitcnt vmcnt(19)
  buffer_load_dwordx2 v[122:123], v28, s[40:43], s4 offen offset:0 nt
  s_waitcnt vmcnt(19)
  buffer_load_dwordx2 v[124:125], v28, s[36:39], s4 offen offset:3584 nt
  s_waitcnt vmcnt(19)
  buffer_load_dwordx2 v[126:127], v28, s[40:43], s4 offen offset:3584 nt
  s_add_u32 s4, s86, 114688
  s_waitcnt vmcnt(19)
  buffer_load_dwordx2 v[128:129], v28, s[36:39], s4 offen offset:0 nt
  s_waitcnt vmcnt(19)
  buffer_load_dwordx2 v[130:131], v28, s[40:43], s4 offen offset:0 nt
  s_waitcnt vmcnt(19)
  buffer_load_dwordx2 v[132:133], v28, s[36:39], s4 offen offset:3584 nt
  s_waitcnt vmcnt(19)
  buffer_load_dwordx2 v[134:135], v28, s[40:43], s4 offen offset:3584 nt
  s_add_u32 s4, s86, 143360
  s_waitcnt vmcnt(19)
  buffer_load_dwordx2 v[136:137], v28, s[36:39], s4 offen offset:0 nt
  s_waitcnt vmcnt(19)
  buffer_load_dwordx2 v[138:139], v28, s[40:43], s4 offen offset:0 nt
  s_waitcnt vmcnt(19)
  buffer_load_dwordx2 v[140:141], v28, s[36:39], s4 offen offset:3584 nt
  s_waitcnt vmcnt(19)
  buffer_load_dwordx2 v[142:143], v28, s[40:43], s4 offen offset:3584 nt
  s_add_u32 s4, s86, 129024
  s_waitcnt vmcnt(19)
  buffer_load_dwordx2 v[144:145], v28, s[36:39], s4 offen offset:0 nt
  s_waitcnt vmcnt(19)
  buffer_load_dwordx2 v[146:147], v28, s[40:43], s4 offen offset:0 nt
  s_waitcnt vmcnt(19)
  buffer_load_dwordx2 v[148:149], v28, s[36:39], s4 offen offset:3584 nt
  s_waitcnt vmcnt(19)
  buffer_load_dwordx2 v[150:151], v28, s[40:43], s4 offen offset:3584 nt
  s_add_u32 s4, s86, 157696
  s_waitcnt vmcnt(19)
  buffer_load_dwordx2 v[152:153], v28, s[36:39], s4 offen offset:0 nt
  s_waitcnt vmcnt(19)
  buffer_load_dwordx2 v[154:155], v28, s[40:43], s4 offen offset:0 nt
  s_waitcnt vmcnt(19)
  buffer_load_dwordx2 v[156:157], v28, s[36:39], s4 offen offset:3584 nt
  s_waitcnt vmcnt(19)
  buffer_load_dwordx2 v[158:159], v28, s[40:43], s4 offen offset:3584 nt
  s_add_u32 s4, s86, 229376
  s_waitcnt vmcnt(19)
  buffer_load_dwordx2 v[160:161], v28, s[36:39], s4 offen offset:0 nt
  s_waitcnt vmcnt(19)
  buffer_load_dwordx2 v[162:163], v28, s[40:43], s4 offen offset:0 nt
  s_waitcnt vmcnt(19)
  buffer_load_dwordx2 v[164:165], v28, s[36:39], s4 offen offset:3584 nt
  s_waitcnt vmcnt(19)
  buffer_load_dwordx2 v[166:167], v28, s[40:43], s4 offen offset:3584 nt
  s_add_u32 s4, s86, 258048
  s_waitcnt vmcnt(19)
  buffer_load_dwordx2 v[168:169], v28, s[36:39], s4 offen offset:0 nt
  s_waitcnt vmcnt(19)
  buffer_load_dwordx2 v[170:171], v28, s[40:43], s4 offen offset:0 nt
  s_waitcnt vmcnt(19)
  buffer_load_dwordx2 v[172:173], v28, s[36:39], s4 offen offset:3584 nt
  s_waitcnt vmcnt(19)
  buffer_load_dwordx2 v[174:175], v28, s[40:43], s4 offen offset:3584 nt
  s_add_u32 s4, s86, 243712
  s_waitcnt vmcnt(19)
  buffer_load_dwordx2 v[176:177], v28, s[36:39], s4 offen offset:0 nt
  s_waitcnt vmcnt(19)
  buffer_load_dwordx2 v[178:179], v28, s[40:43], s4 offen offset:0 nt
  s_waitcnt vmcnt(19)
  buffer_load_dwordx2 v[180:181], v28, s[36:39], s4 offen offset:3584 nt
  s_waitcnt vmcnt(19)
  buffer_load_dwordx2 v[182:183], v28, s[40:43], s4 offen offset:3584 nt
  s_add_u32 s4, s86, 272384
  s_waitcnt vmcnt(19)
  buffer_load_dwordx2 v[184:185], v28, s[36:39], s4 offen offset:0 nt
  s_waitcnt vmcnt(19)
  buffer_load_dwordx2 v[186:187], v28, s[40:43], s4 offen offset:0 nt
  s_waitcnt vmcnt(19)
  buffer_load_dwordx2 v[188:189], v28, s[36:39], s4 offen offset:3584 nt
  s_waitcnt vmcnt(19)
  buffer_load_dwordx2 v[190:191], v28, s[40:43], s4 offen offset:3584 nt
  s_add_u32 s4, s86, 344064
  s_waitcnt vmcnt(19)
  buffer_load_dwordx2 v[192:193], v28, s[36:39], s4 offen offset:0 nt
  s_waitcnt vmcnt(19)
  buffer_load_dwordx2 v[194:195], v28, s[40:43], s4 offen offset:0 nt
  s_waitcnt vmcnt(19)
  buffer_load_dwordx2 v[196:197], v28, s[36:39], s4 offen offset:3584 nt
  s_waitcnt vmcnt(19)
  buffer_load_dwordx2 v[198:199], v28, s[40:43], s4 offen offset:3584 nt
  s_add_u32 s4, s86, 372736
  s_waitcnt vmcnt(19)
  buffer_load_dwordx2 v[200:201], v28, s[36:39], s4 offen offset:0 nt
  s_waitcnt vmcnt(19)
  buffer_load_dwordx2 v[202:203], v28, s[40:43], s4 offen offset:0 nt
  s_waitcnt vmcnt(19)
  buffer_load_dwordx2 v[204:205], v28, s[36:39], s4 offen offset:3584 nt
  s_waitcnt vmcnt(19)
  buffer_load_dwordx2 v[206:207], v28, s[40:43], s4 offen offset:3584 nt
  s_add_u32 s4, s86, 358400
  s_waitcnt vmcnt(19)
  buffer_load_dwordx2 v[208:209], v28, s[36:39], s4 offen offset:0 nt
  s_waitcnt vmcnt(19)
  buffer_load_dwordx2 v[210:211], v28, s[40:43], s4 offen offset:0 nt
  s_waitcnt vmcnt(19)
  buffer_load_dwordx2 v[212:213], v28, s[36:39], s4 offen offset:3584 nt
  s_waitcnt vmcnt(19)
  buffer_load_dwordx2 v[214:215], v28, s[40:43], s4 offen offset:3584 nt
  s_add_u32 s4, s86, 387072
  s_waitcnt vmcnt(19)
  buffer_load_dwordx2 v[216:217], v28, s[36:39], s4 offen offset:0 nt
  s_waitcnt vmcnt(19)
  buffer_load_dwordx2 v[218:219], v28, s[40:43], s4 offen offset:0 nt
  s_waitcnt vmcnt(19)
  buffer_load_dwordx2 v[220:221], v28, s[36:39], s4 offen offset:3584 nt
  s_waitcnt vmcnt(19)
  buffer_load_dwordx2 v[222:223], v28, s[40:43], s4 offen offset:3584 nt
  s_add_u32 s4, s85, 0
  s_waitcnt vmcnt(9)
  buffer_load_dwordx4 v[224:227], v29, s[44:47], s4 offen offset:0 nt
  s_waitcnt vmcnt(9)
  buffer_load_dwordx4 v[240:243], v29, s[44:47], s4 offen offset:2048 nt
  s_add_u32 s4, s85, 4096
  s_waitcnt vmcnt(9)
  buffer_load_dwordx4 v[228:231], v29, s[44:47], s4 offen offset:0 nt
  s_waitcnt vmcnt(9)
  buffer_load_dwordx4 v[244:247], v29, s[44:47], s4 offen offset:2048 nt
  s_add_u32 s4, s85, 8192
  s_waitcnt vmcnt(9)
  buffer_load_dwordx4 v[232:235], v29, s[44:47], s4 offen offset:0 nt
  s_waitcnt vmcnt(9)
  buffer_load_dwordx4 v[248:251], v29, s[44:47], s4 offen offset:2048 nt
  s_add_u32 s4, s85, 12288
  s_waitcnt vmcnt(9)
  buffer_load_dwordx4 v[236:239], v29, s[44:47], s4 offen offset:0 nt
  s_waitcnt vmcnt(9)
  buffer_load_dwordx4 v[252:255], v29, s[44:47], s4 offen offset:2048 nt
  s_add_u32 s4, s85, 32768
  s_waitcnt vmcnt(9)
  buffer_load_dwordx4 v[32:35], v29, s[44:47], s4 offen offset:0 nt
  s_waitcnt vmcnt(9)
  buffer_load_dwordx4 v[48:51], v29, s[44:47], s4 offen offset:2048 nt
  s_add_u32 s4, s85, 36864
  s_waitcnt vmcnt(9)
  buffer_load_dwordx4 v[36:39], v29, s[44:47], s4 offen offset:0 nt
  s_waitcnt vmcnt(9)
  buffer_load_dwordx4 v[52:55], v29, s[44:47], s4 offen offset:2048 nt
  s_add_u32 s4, s85, 40960
  s_waitcnt vmcnt(9)
  buffer_load_dwordx4 v[40:43], v29, s[44:47], s4 offen offset:0 nt
  s_waitcnt vmcnt(9)
  buffer_load_dwordx4 v[56:59], v29, s[44:47], s4 offen offset:2048 nt
  s_add_u32 s4, s85, 45056
  s_waitcnt vmcnt(9)
  buffer_load_dwordx4 v[44:47], v29, s[44:47], s4 offen offset:0 nt
  s_waitcnt vmcnt(9)
  buffer_load_dwordx4 v[60:63], v29, s[44:47], s4 offen offset:2048 nt
  s_mov_b64 s[64:65], 0
  s_mov_b64 s[66:67], 0
  s_mov_b64 s[68:69], 0
  s_mov_b64 s[70:71], 0
  s_lshr_b32 s4, s3, 1
  s_lshl_b32 s4, s4, 16
  s_and_b32 s72, s3, 1
  s_mul_i32 s72, s72, 0x2200
  s_add_u32 s4, s4, s72
  s_add_u32 s4, s4, s6
  s_xor_b32 s72, s4, 0x2000
  s_waitcnt lgkmcnt(0)
  s_buffer_load_dword s64, s[16:19], s4 offset:0x20000
  s_buffer_load_dword s66, s[16:19], s4 offset:0x20080
  s_buffer_load_dword s68, s[16:19], s4 offset:0x20100
  s_buffer_load_dword s70, s[16:19], s4 offset:0x20180
  s_buffer_load_dword s65, s[16:19], s72 offset:0x20000
  s_buffer_load_dword s67, s[16:19], s72 offset:0x20080
  s_buffer_load_dword s69, s[16:19], s72 offset:0x20100
  s_buffer_load_dword s71, s[16:19], s72 offset:0x20180
  s_waitcnt lgkmcnt(4)
  s_nop 7
  s_sub_u32 s73, s65, s64
  s_sub_u32 s72, s67, s66
  s_sub_u32 s4, s69, s68
  s_sub_u32 s61, s71, s70
  s_add_u32 s73, s73, s72
  s_add_u32 s4, s4, s61
  s_add_u32 s73, s73, s4
  s_sub_u32 s4, 0, s73
  s_bitcmp1_b32 s3, 0
  s_cselect_b32 s73, s4, s73
  s_waitcnt lgkmcnt(0)
  s_getreg_b32 s65, hwreg(HW_REG_XCC_ID, 2, 1)
  s_sub_u32 s4, 0, s73
  s_lshl_b32 s65, s65, 13
  s_cselect_b32 s73, s4, s73
  s_xor_b32 s66, s65, 0x2000
  v_mov_b32 v11, s73
  s_mov_b64 exec, 1
  buffer_atomic_add v11, off, s[20:23], 0 offset:128 sc1
  s_mov_b64 exec, -1
  v_accvgpr_mov_b32 a128, a160
  v_accvgpr_mov_b32 a129, a164
  v_accvgpr_mov_b32 a130, a168
  v_accvgpr_mov_b32 a131, a172
  v_accvgpr_mov_b32 a132, a176
  v_accvgpr_mov_b32 a133, a180
  v_accvgpr_mov_b32 a134, a184
  v_accvgpr_mov_b32 a135, a188
  v_accvgpr_mov_b32 a136, a161
  v_accvgpr_mov_b32 a137, a165
  v_accvgpr_mov_b32 a138, a169
  v_accvgpr_mov_b32 a139, a173
  v_accvgpr_mov_b32 a140, a177
  v_accvgpr_mov_b32 a141, a181
  v_accvgpr_mov_b32 a142, a185
  v_accvgpr_mov_b32 a143, a189
  v_accvgpr_mov_b32 a144, a162
  v_accvgpr_mov_b32 a145, a166
  v_accvgpr_mov_b32 a146, a170
  v_accvgpr_mov_b32 a147, a174
  v_accvgpr_mov_b32 a148, a178
  v_accvgpr_mov_b32 a149, a182
  v_accvgpr_mov_b32 a150, a186
  v_accvgpr_mov_b32 a151, a190
  v_accvgpr_mov_b32 a152, a163
  v_accvgpr_mov_b32 a153, a167
  v_accvgpr_mov_b32 a154, a171
  v_accvgpr_mov_b32 a155, a175
  v_accvgpr_mov_b32 a156, a179
  v_accvgpr_mov_b32 a157, a183
  v_accvgpr_mov_b32 a158, a187
  v_accvgpr_mov_b32 a159, a191
  v_accvgpr_mov_b32 a160, a192
  v_accvgpr_mov_b32 a161, a196
  v_accvgpr_mov_b32 a162, a200
  v_accvgpr_mov_b32 a163, a204
  v_accvgpr_mov_b32 a164, a208
  v_accvgpr_mov_b32 a165, a212
  v_accvgpr_mov_b32 a166, a216
  v_accvgpr_mov_b32 a167, a220
  v_accvgpr_mov_b32 a168, a193
  v_accvgpr_mov_b32 a169, a197
  v_accvgpr_mov_b32 a170, a201
  v_accvgpr_mov_b32 a171, a205
  v_accvgpr_mov_b32 a172, a209
  v_accvgpr_mov_b32 a173, a213
  v_accvgpr_mov_b32 a174, a217
  v_accvgpr_mov_b32 a175, a221
  v_accvgpr_mov_b32 a176, a194
  v_accvgpr_mov_b32 a177, a198
  v_accvgpr_mov_b32 a178, a202
  v_accvgpr_mov_b32 a179, a206
  v_accvgpr_mov_b32 a180, a210
  v_accvgpr_mov_b32 a181, a214
  v_accvgpr_mov_b32 a182, a218
  v_accvgpr_mov_b32 a183, a222
  v_accvgpr_mov_b32 a184, a195
  v_accvgpr_mov_b32 a185, a199
  v_accvgpr_mov_b32 a186, a203
  v_accvgpr_mov_b32 a187, a207
  v_accvgpr_mov_b32 a188, a211
  v_accvgpr_mov_b32 a189, a215
  v_accvgpr_mov_b32 a190, a219
  v_accvgpr_mov_b32 a191, a223
  v_accvgpr_mov_b32 a192, a224
  v_accvgpr_mov_b32 a193, a228
  v_accvgpr_mov_b32 a194, a232
  v_accvgpr_mov_b32 a195, a236
  v_accvgpr_mov_b32 a196, a240
  v_accvgpr_mov_b32 a197, a244
  v_accvgpr_mov_b32 a198, a248
  v_accvgpr_mov_b32 a199, a252
  v_accvgpr_mov_b32 a200, a225
  v_accvgpr_mov_b32 a201, a229
  v_accvgpr_mov_b32 a202, a233
  v_accvgpr_mov_b32 a203, a237
  v_accvgpr_mov_b32 a204, a241
  v_accvgpr_mov_b32 a205, a245
  v_accvgpr_mov_b32 a206, a249
  v_accvgpr_mov_b32 a207, a253
  v_accvgpr_mov_b32 a208, a226
  v_accvgpr_mov_b32 a209, a230
  v_accvgpr_mov_b32 a210, a234
  v_accvgpr_mov_b32 a211, a238
  v_accvgpr_mov_b32 a212, a242
  v_accvgpr_mov_b32 a213, a246
  v_accvgpr_mov_b32 a214, a250
  v_accvgpr_mov_b32 a215, a254
  v_accvgpr_mov_b32 a216, a227
  v_accvgpr_mov_b32 a217, a231
  v_accvgpr_mov_b32 a218, a235
  v_accvgpr_mov_b32 a219, a239
  v_accvgpr_mov_b32 a220, a243
  v_accvgpr_mov_b32 a221, a247
  v_accvgpr_mov_b32 a222, a251
  v_accvgpr_mov_b32 a223, a255
  v_accvgpr_write_b32 a224, v64
  v_accvgpr_write_b32 a225, v68
  v_accvgpr_write_b32 a226, v72
  v_accvgpr_write_b32 a227, v76
  v_accvgpr_write_b32 a228, v80
  v_accvgpr_write_b32 a229, v84
  v_accvgpr_write_b32 a230, v88
  v_accvgpr_write_b32 a231, v92
  v_accvgpr_write_b32 a232, v65
  v_accvgpr_write_b32 a233, v69
  v_accvgpr_write_b32 a234, v73
  v_accvgpr_write_b32 a235, v77
  v_accvgpr_write_b32 a236, v81
  v_accvgpr_write_b32 a237, v85
  v_accvgpr_write_b32 a238, v89
  v_accvgpr_write_b32 a239, v93
  v_accvgpr_write_b32 a240, v66
  v_accvgpr_write_b32 a241, v70
  v_accvgpr_write_b32 a242, v74
  v_accvgpr_write_b32 a243, v78
  v_accvgpr_write_b32 a244, v82
  v_accvgpr_write_b32 a245, v86
  v_accvgpr_write_b32 a246, v90
  v_accvgpr_write_b32 a247, v94
  v_accvgpr_write_b32 a248, v67
  v_accvgpr_write_b32 a249, v71
  v_accvgpr_write_b32 a250, v75
  v_accvgpr_write_b32 a251, v79
  v_accvgpr_write_b32 a252, v83
  v_accvgpr_write_b32 a253, v87
  v_accvgpr_write_b32 a254, v91
  v_accvgpr_write_b32 a255, v95
  s_mov_b32 s4, 0x05040100
  s_mov_b32 s61, 0x07060302
  s_waitcnt vmcnt(0)
  v_perm_b32 v64, v98, v96, s4
  v_perm_b32 v65, v102, v100, s4
  v_perm_b32 v66, v106, v104, s4
  v_perm_b32 v67, v110, v108, s4
  v_perm_b32 v68, v114, v112, s4
  v_perm_b32 v69, v118, v116, s4
  v_perm_b32 v70, v122, v120, s4
  v_perm_b32 v71, v126, v124, s4
  v_perm_b32 v72, v98, v96, s61
  v_perm_b32 v73, v102, v100, s61
  v_perm_b32 v74, v106, v104, s61
  v_perm_b32 v75, v110, v108, s61
  v_perm_b32 v76, v114, v112, s61
  v_perm_b32 v77, v118, v116, s61
  v_perm_b32 v78, v122, v120, s61
  v_perm_b32 v79, v126, v124, s61
  v_perm_b32 v80, v99, v97, s4
  v_perm_b32 v81, v103, v101, s4
  v_perm_b32 v82, v107, v105, s4
  v_perm_b32 v83, v111, v109, s4
  v_perm_b32 v84, v115, v113, s4
  v_perm_b32 v85, v119, v117, s4
  v_perm_b32 v86, v123, v121, s4
  v_perm_b32 v87, v127, v125, s4
  v_perm_b32 v88, v99, v97, s61
  v_perm_b32 v89, v103, v101, s61
  v_perm_b32 v90, v107, v105, s61
  v_perm_b32 v91, v111, v109, s61
  v_perm_b32 v92, v115, v113, s61
  v_perm_b32 v93, v119, v117, s61
  v_perm_b32 v94, v123, v121, s61
  v_perm_b32 v95, v127, v125, s61
  v_perm_b32 v96, v130, v128, s4
  v_perm_b32 v97, v134, v132, s4
  v_perm_b32 v98, v138, v136, s4
  v_perm_b32 v99, v142, v140, s4
  v_perm_b32 v100, v146, v144, s4
  v_perm_b32 v101, v150, v148, s4
  v_perm_b32 v102, v154, v152, s4
  v_perm_b32 v103, v158, v156, s4
  v_perm_b32 v104, v130, v128, s61
  v_perm_b32 v105, v134, v132, s61
  v_perm_b32 v106, v138, v136, s61
  v_perm_b32 v107, v142, v140, s61
  v_perm_b32 v108, v146, v144, s61
  v_perm_b32 v109, v150, v148, s61
  v_perm_b32 v110, v154, v152, s61
  v_perm_b32 v111, v158, v156, s61
  v_perm_b32 v112, v131, v129, s4
  v_perm_b32 v113, v135, v133, s4
  v_perm_b32 v114, v139, v137, s4
  v_perm_b32 v115, v143, v141, s4
  v_perm_b32 v116, v147, v145, s4
  v_perm_b32 v117, v151, v149, s4
  v_perm_b32 v118, v155, v153, s4
  v_perm_b32 v119, v159, v157, s4
  v_perm_b32 v120, v131, v129, s61
  v_perm_b32 v121, v135, v133, s61
  v_perm_b32 v122, v139, v137, s61
  v_perm_b32 v123, v143, v141, s61
  v_perm_b32 v124, v147, v145, s61
  v_perm_b32 v125, v151, v149, s61
  v_perm_b32 v126, v155, v153, s61
  v_perm_b32 v127, v159, v157, s61
  v_perm_b32 v128, v162, v160, s4
  v_perm_b32 v129, v166, v164, s4
  v_perm_b32 v130, v170, v168, s4
  v_perm_b32 v131, v174, v172, s4
  v_perm_b32 v132, v178, v176, s4
  v_perm_b32 v133, v182, v180, s4
  v_perm_b32 v134, v186, v184, s4
  v_perm_b32 v135, v190, v188, s4
  v_perm_b32 v136, v162, v160, s61
  v_perm_b32 v137, v166, v164, s61
  v_perm_b32 v138, v170, v168, s61
  v_perm_b32 v139, v174, v172, s61
  v_perm_b32 v140, v178, v176, s61
  v_perm_b32 v141, v182, v180, s61
  v_perm_b32 v142, v186, v184, s61
  v_perm_b32 v143, v190, v188, s61
  v_perm_b32 v144, v163, v161, s4
  v_perm_b32 v145, v167, v165, s4
  v_perm_b32 v146, v171, v169, s4
  v_perm_b32 v147, v175, v173, s4
  v_perm_b32 v148, v179, v177, s4
  v_perm_b32 v149, v183, v181, s4
  v_perm_b32 v150, v187, v185, s4
  v_perm_b32 v151, v191, v189, s4
  v_perm_b32 v152, v163, v161, s61
  v_perm_b32 v153, v167, v165, s61
  v_perm_b32 v154, v171, v169, s61
  v_perm_b32 v155, v175, v173, s61
  v_perm_b32 v156, v179, v177, s61
  v_perm_b32 v157, v183, v181, s61
  v_perm_b32 v158, v187, v185, s61
  v_perm_b32 v159, v191, v189, s61
  v_perm_b32 v160, v194, v192, s4
  v_perm_b32 v161, v198, v196, s4
  v_perm_b32 v162, v202, v200, s4
  v_perm_b32 v163, v206, v204, s4
  v_perm_b32 v164, v210, v208, s4
  v_perm_b32 v165, v214, v212, s4
  v_perm_b32 v166, v218, v216, s4
  v_perm_b32 v167, v222, v220, s4
  v_perm_b32 v168, v194, v192, s61
  v_perm_b32 v169, v198, v196, s61
  v_perm_b32 v170, v202, v200, s61
  v_perm_b32 v171, v206, v204, s61
  v_perm_b32 v172, v210, v208, s61
  v_perm_b32 v173, v214, v212, s61
  v_perm_b32 v174, v218, v216, s61
  v_perm_b32 v175, v222, v220, s61
  v_perm_b32 v176, v195, v193, s4
  v_perm_b32 v177, v199, v197, s4
  v_perm_b32 v178, v203, v201, s4
  v_perm_b32 v179, v207, v205, s4
  v_perm_b32 v180, v211, v209, s4
  v_perm_b32 v181, v215, v213, s4
  v_perm_b32 v182, v219, v217, s4
  v_perm_b32 v183, v223, v221, s4
  v_perm_b32 v184, v195, v193, s61
  v_perm_b32 v185, v199, v197, s61
  v_perm_b32 v186, v203, v201, s61
  v_perm_b32 v187, v207, v205, s61
  v_perm_b32 v188, v211, v209, s61
  v_perm_b32 v189, v215, v213, s61
  v_perm_b32 v190, v219, v217, s61
  v_perm_b32 v191, v223, v221, s61
  v_mov_b32 v192, v224
  v_mov_b32 v193, v228
  v_mov_b32 v194, v232
  v_mov_b32 v195, v236
  v_mov_b32 v196, v240
  v_mov_b32 v197, v244
  v_mov_b32 v198, v248
  v_mov_b32 v199, v252
  v_mov_b32 v200, v225
  v_mov_b32 v201, v229
  v_mov_b32 v202, v233
  v_mov_b32 v203, v237
  v_mov_b32 v204, v241
  v_mov_b32 v205, v245
  v_mov_b32 v206, v249
  v_mov_b32 v207, v253
  v_mov_b32 v208, v226
  v_mov_b32 v209, v230
  v_mov_b32 v210, v234
  v_mov_b32 v211, v238
  v_mov_b32 v212, v242
  v_mov_b32 v213, v246
  v_mov_b32 v214, v250
  v_mov_b32 v215, v254
  v_mov_b32 v216, v227
  v_mov_b32 v217, v231
  v_mov_b32 v218, v235
  v_mov_b32 v219, v239
  v_mov_b32 v220, v243
  v_mov_b32 v221, v247
  v_mov_b32 v222, v251
  v_mov_b32 v223, v255
  v_mov_b32 v224, v32
  v_mov_b32 v225, v36
  v_mov_b32 v226, v40
  v_mov_b32 v227, v44
  v_mov_b32 v228, v48
  v_mov_b32 v229, v52
  v_mov_b32 v230, v56
  v_mov_b32 v231, v60
  v_mov_b32 v232, v33
  v_mov_b32 v233, v37
  v_mov_b32 v234, v41
  v_mov_b32 v235, v45
  v_mov_b32 v236, v49
  v_mov_b32 v237, v53
  v_mov_b32 v238, v57
  v_mov_b32 v239, v61
  v_mov_b32 v240, v34
  v_mov_b32 v241, v38
  v_mov_b32 v242, v42
  v_mov_b32 v243, v46
  v_mov_b32 v244, v50
  v_mov_b32 v245, v54
  v_mov_b32 v246, v58
  v_mov_b32 v247, v62
  v_mov_b32 v248, v35
  v_mov_b32 v249, v39
  v_mov_b32 v250, v43
  v_mov_b32 v251, v47
  v_mov_b32 v252, v51
  v_mov_b32 v253, v55
  v_mov_b32 v254, v59
  v_mov_b32 v255, v63
  v_add_u32 v11, s92, v2
  ds_write_b128 v11, v[240:243] offset:0
  ds_write_b128 v11, v[244:247] offset:1024
  ds_write_b128 v11, v[248:251] offset:2048
  ds_write_b128 v11, v[252:255] offset:3072
  s_waitcnt lgkmcnt(0)
  s_mov_b32 s89, 0
  s_mov_b32 s98, 0
  s_mov_b32 s87, 0
  s_branch L_A
L_aret0:
  v_mov_b32 v32, s78
  v_mov_b32 v33, s78
  v_mov_b32 v34, s78
  v_mov_b32 v35, s78
  v_mov_b64 v[240:241], 0
  v_mov_b64 v[244:245], 0
  v_mov_b64 v[248:249], 0
  v_mov_b64 v[252:253], 0
  v_smfmac_f32_16x16x64_bf16 v[240:243], v[32:35], v[64:71], v7
  v_smfmac_f32_16x16x64_bf16 v[244:247], v[32:35], v[72:79], v7
  v_smfmac_f32_16x16x64_bf16 v[248:251], v[32:35], v[80:87], v7
  v_smfmac_f32_16x16x64_bf16 v[252:255], v[32:35], v[88:95], v7
  v_smfmac_f32_16x16x64_bf16 v[240:243], v[32:35], v[96:103], v7
  v_smfmac_f32_16x16x64_bf16 v[244:247], v[32:35], v[104:111], v7
  v_smfmac_f32_16x16x64_bf16 v[248:251], v[32:35], v[112:119], v7
  v_smfmac_f32_16x16x64_bf16 v[252:255], v[32:35], v[120:127], v7
  v_smfmac_f32_16x16x64_bf16 v[240:243], v[32:35], v[128:135], v7
  v_smfmac_f32_16x16x64_bf16 v[244:247], v[32:35], v[136:143], v7
  v_smfmac_f32_16x16x64_bf16 v[248:251], v[32:35], v[144:151], v7
  v_smfmac_f32_16x16x64_bf16 v[252:255], v[32:35], v[152:159], v7
  v_smfmac_f32_16x16x64_bf16 v[240:243], v[32:35], v[160:167], v7
  v_smfmac_f32_16x16x64_bf16 v[244:247], v[32:35], v[168:175], v7
  v_smfmac_f32_16x16x64_bf16 v[248:251], v[32:35], v[176:183], v7
  v_smfmac_f32_16x16x64_bf16 v[252:255], v[32:35], v[184:191], v7
  v_mov_b32 v53, 0
  s_mov_b64 exec, 0xffff
  s_nop 3
  ds_write2_b64 v5, v[240:241], v[244:245] offset0:0 offset1:32
  s_nop 0
  ds_write2_b64 v5, v[248:249], v[252:253] offset0:64 offset1:96
  s_mov_b64 exec, -1
  s_waitcnt lgkmcnt(0)
  s_barrier
  ds_read_b128 v[248:251], v2 offset:0
  ds_read_b128 v[252:255], v2 offset:1024
  s_waitcnt lgkmcnt(0)
  v_pk_add_f32 v[248:249], v[248:249], v[250:251]
  v_pk_add_f32 v[252:253], v[252:253], v[254:255]
  v_pk_add_f32 v[248:249], v[248:249], v[252:253]
  v_mov_b32 v12, v248
  v_mov_b32 v13, v249
  v_and_b32 v32, 0x1f0, v2
  v_lshrrev_b32 v32, 2, v32
  s_mov_b32 s61, 0
  s_nop 0
L_flags:
  buffer_load_dword v33, v32, s[20:23], 0 offen sc1
  s_waitcnt vmcnt(0)
  v_cmp_eq_u32 vcc, 0, v33
  s_nop 0
  s_cbranch_vccz L_flags_ok
  s_add_u32 s61, s61, 1
  s_cmp_gt_u32 s61, 20000
  s_cbranch_scc1 L_flags_ok
  s_sleep 4
  s_branch L_flags
L_flags_ok:
  s_getreg_b32 s61, hwreg(HW_REG_XCC_ID, 0, 4)
  s_add_u32 s61, s61, 1
  v_cmp_eq_u32 vcc, s61, v33
  s_and_b32 s86, s2, 7
  s_lshl_b32 s4, s86, 2
  s_lshr_b32 s87, vcc_lo, s4
  s_and_b32 s87, s87, 15
  s_lshr_b32 s61, s2, 3
  s_add_u32 s86, s4, s61
  s_lshl_b32 s86, s86, 8
  s_and_b32 s4, s3, 1
  s_lshl_b32 s4, s4, 13
  s_add_u32 s86, s86, s4
  s_mov_b32 s99, 0
  s_mov_b32 s93, 0x600000
L_chain:
  s_barrier
  v_mov_b64 v[248:249], -1
  v_mov_b64 v[250:251], -1
  v_lshl_add_u32 v252, s62, 2, v2
  v_lshrrev_b32 v253, 1, v252
  ds_write_b128 v252, v[248:251] offset:0
  ds_write_b128 v252, v[248:251] offset:4096
  ds_write_b64 v253, v[248:249] offset:8192
  s_waitcnt lgkmcnt(0)
  s_barrier
  s_mov_b32 s61, 0
  s_add_u32 s94, s5, 4096
  s_cmp_eq_u32 s99, 2
  s_cbranch_scc1 L_wm
L_wmr:
  buffer_load_dwordx4 v[240:243], v10, s[16:19], s5 offen sc1
  s_sleep 2
L_ml:
  buffer_load_dwordx4 v[240:243], v10, s[16:19], s5 offen sc1
  s_waitcnt vmcnt(1)
  v_max3_u32 v244, v240, v241, v242
  v_max_u32 v244, v244, v243
  v_cmp_eq_u32 vcc, -1, v244
  s_cbranch_vccnz L_ml_re
L_ml_go:
  s_buffer_load_dword s64, s[20:23], 0x80
  v_max_f32_dpp v244, v240, v240 quad_perm:[1,0,3,2] row_mask:0xf bank_mask:0xf
  v_add_f32 v247, v241, v243
  v_mov_b64 v[28:29], 0
  v_max_f32_dpp v244, v244, v244 quad_perm:[2,3,0,1] row_mask:0xf bank_mask:0xf
  v_mov_b64 v[30:31], 0
  v_mov_b64 v[16:17], 0
  v_max_f32_dpp v244, v244, v244 row_ror:8 row_mask:0xf bank_mask:0xf
  v_mov_b32 v245, v244
  v_mov_b64 v[18:19], 0
  s_nop 0
  v_permlane32_swap_b32 v244, v245
  v_max_f32 v244, v244, v245
  v_mov_b32 v245, v244
  s_nop 1
  v_permlane16_swap_b32 v244, v245
  v_max_f32 v244, v244, v245
  v_sub_f32 v246, v240, v244
  v_exp_f32 v246, v246
  s_nop 0
  v_mul_f32 v247, v247, v246
  s_nop 1
  v_add_f32_dpp v247, v247, v247 row_ror:8 row_mask:0xf bank_mask:0xf
  s_nop 1
  v_add_f32_dpp v247, v247, v247 row_ror:4 row_mask:0xf bank_mask:0xf
  s_nop 1
  v_add_f32_dpp v247, v247, v247 row_ror:2 row_mask:0xf bank_mask:0xf
  s_nop 1
  v_add_f32_dpp v247, v247, v247 row_ror:1 row_mask:0xf bank_mask:0xf
  v_mov_b32 v245, v247
  s_nop 1
  v_permlane32_swap_b32 v247, v245
  v_add_f32 v247, v247, v245
  v_mov_b32 v245, v247
  s_nop 1
  v_permlane16_swap_b32 v247, v245
  v_add_f32 v247, v247, v245
  v_rcp_f32 v247, v247
  s_nop 0
  v_mul_f32 v246, v246, v247
  v_cvt_pk_bf16_f32 v245, v246, 0
  v_lshlrev_b32 v245, 16, v245
  v_sub_f32 v245, v246, v245
  v_cvt_pk_bf16_f32 v246, v246, v245
  s_nop 1
  v_mov_b32_dpp v20, v246 quad_perm:[0,1,0,1] row_mask:0xf bank_mask:0x3
  v_mov_b32_dpp v22, v246 quad_perm:[2,3,2,3] row_mask:0xf bank_mask:0x3
  v_mov_b32_dpp v25, v246 quad_perm:[0,1,0,1] row_mask:0xf bank_mask:0xc
  v_mov_b32_dpp v27, v246 quad_perm:[2,3,2,3] row_mask:0xf bank_mask:0xc
  v_mov_b32_dpp v21, v20 row_ror:8 row_mask:0xf bank_mask:0xc
  v_mov_b32_dpp v23, v22 row_ror:8 row_mask:0xf bank_mask:0xc
  v_mov_b32_dpp v24, v25 row_ror:8 row_mask:0xf bank_mask:0x3
  v_mov_b32_dpp v26, v27 row_ror:8 row_mask:0xf bank_mask:0x3
  s_mov_b32 s61, 0
  s_nop 0
L_rp:
  buffer_load_dwordx4 v[32:35], v4, s[16:19], s5 offen offset:0 sc1
  buffer_load_dwordx4 v[36:39], v4, s[16:19], s5 offen offset:2048 sc1
  buffer_load_dwordx4 v[40:43], v4, s[16:19], s5 offen offset:128 sc1
  buffer_load_dwordx4 v[44:47], v4, s[16:19], s5 offen offset:2176 sc1
  buffer_load_dwordx4 v[48:51], v4, s[16:19], s94 offen offset:0 sc1
  buffer_load_dwordx4 v[52:55], v4, s[16:19], s94 offen offset:2048 sc1
  buffer_load_dwordx4 v[56:59], v4, s[16:19], s94 offen offset:128 sc1
  buffer_load_dwordx4 v[60:63], v4, s[16:19], s94 offen offset:2176 sc1
  s_mov_b64 exec, -1
L_rp_w:
  s_waitcnt vmcnt(6)
  v_smfmac_f32_16x16x64_bf16 v[28:31], v[20:23], v[32:39], v7 abid:1
  v_max_u32 v11, v32, v36
  s_waitcnt vmcnt(4)
  v_smfmac_f32_16x16x64_bf16 v[16:19], v[20:23], v[40:47], v7 abid:1
  v_max3_u32 v11, v11, v40, v44
  s_waitcnt vmcnt(2)
  v_smfmac_f32_16x16x64_bf16 v[28:31], v[24:27], v[48:55], v7 abid:1
  v_max3_u32 v11, v11, v48, v52
  s_waitcnt vmcnt(0)
  v_smfmac_f32_16x16x64_bf16 v[16:19], v[24:27], v[56:63], v7 abid:1
  v_max3_u32 v11, v11, v56, v60
  v_cmp_eq_u32 vcc, -1, v11
  v_mov_b64 v[240:241], 0
  v_mov_b64 v[244:245], 0
  v_mov_b64 v[248:249], 0
  v_add_f32_dpp v28, v29, v28 row_ror:8 row_mask:0xf bank_mask:0x3
  v_add_f32_dpp v30, v31, v30 row_ror:8 row_mask:0xf bank_mask:0x3
  v_mov_b64 v[252:253], 0
  s_cbranch_vccnz L_rp_re
L_rp_go:
  v_add_f32_dpp v28, v16, v17 row_ror:8 row_mask:0xf bank_mask:0xc
  v_add_f32_dpp v30, v18, v19 row_ror:8 row_mask:0xf bank_mask:0xc
  v_cvt_pk_bf16_f32 v50, v28, v30
  v_cmp_u_f32 vcc, v28, v30
  v_mov_b32 v11, 0x3f80
  v_mov_b32_dpp v32, v50 row_newbcast:0 row_mask:0xf bank_mask:0xf
  v_mov_b32_dpp v33, v50 row_newbcast:1 row_mask:0xf bank_mask:0xf
  v_mov_b32_dpp v34, v50 row_newbcast:2 row_mask:0xf bank_mask:0xf
  v_mov_b32_dpp v35, v50 row_newbcast:3 row_mask:0xf bank_mask:0xf
  v_mov_b32_dpp v36, v50 row_newbcast:4 row_mask:0xf bank_mask:0xf
  v_mov_b32_dpp v37, v50 row_newbcast:5 row_mask:0xf bank_mask:0xf
  v_smfmac_f32_16x16x64_bf16 v[240:243], v[32:35], a[128:135], v7
  s_cbranch_vccnz L_rp_re2
L_rp_ok:
  v_mov_b32_dpp v38, v50 row_newbcast:6 row_mask:0xf bank_mask:0xf
  v_smfmac_f32_16x16x64_bf16 v[244:247], v[32:35], a[136:143], v7
  v_mov_b32_dpp v39, v50 row_newbcast:7 row_mask:0xf bank_mask:0xf
  v_smfmac_f32_16x16x64_bf16 v[248:251], v[32:35], a[144:151], v7
  v_mov_b32_dpp v40, v50 row_newbcast:8 row_mask:0xf bank_mask:0xf
  v_smfmac_f32_16x16x64_bf16 v[252:255], v[32:35], a[152:159], v7
  v_mov_b32_dpp v41, v50 row_newbcast:9 row_mask:0xf bank_mask:0xf
  v_smfmac_f32_16x16x64_bf16 v[240:243], v[36:39], a[160:167], v7
  v_mov_b32_dpp v42, v50 row_newbcast:10 row_mask:0xf bank_mask:0xf
  v_smfmac_f32_16x16x64_bf16 v[244:247], v[36:39], a[168:175], v7
  v_mov_b32_dpp v43, v50 row_newbcast:11 row_mask:0xf bank_mask:0xf
  v_smfmac_f32_16x16x64_bf16 v[248:251], v[36:39], a[176:183], v7
  v_mov_b32_dpp v44, v50 row_newbcast:12 row_mask:0xf bank_mask:0xf
  v_smfmac_f32_16x16x64_bf16 v[252:255], v[36:39], a[184:191], v7
  v_mov_b32_dpp v45, v50 row_newbcast:13 row_mask:0xf bank_mask:0xf
  v_smfmac_f32_16x16x64_bf16 v[240:243], v[40:43], a[192:199], v7
  v_mov_b32_dpp v46, v50 row_newbcast:14 row_mask:0xf bank_mask:0xf
  v_smfmac_f32_16x16x64_bf16 v[244:247], v[40:43], a[200:207], v7
  v_mov_b32_dpp v47, v50 row_newbcast:15 row_mask:0xf bank_mask:0xf
  v_smfmac_f32_16x16x64_bf16 v[248:251], v[40:43], a[208:215], v7
  v_smfmac_f32_16x16x64_bf16 v[252:255], v[40:43], a[216:223], v7
  v_mov_b32_dpp v20, v11 quad_perm:[0,1,2,3] row_mask:0xf bank_mask:0x3
  v_smfmac_f32_16x16x64_bf16 v[240:243], v[44:47], a[224:231], v7
  v_mov_b32_dpp v21, v11 quad_perm:[0,1,2,3] row_mask:0xf bank_mask:0xc
  v_smfmac_f32_16x16x64_bf16 v[244:247], v[44:47], a[232:239], v7
  v_mov_b32_dpp v22, v11 quad_perm:[0,1,2,3] row_mask:0xf bank_mask:0x3
  v_smfmac_f32_16x16x64_bf16 v[248:251], v[44:47], a[240:247], v7
  v_mov_b32_dpp v23, v11 quad_perm:[0,1,2,3] row_mask:0xf bank_mask:0xc
  v_smfmac_f32_16x16x64_bf16 v[252:255], v[44:47], a[248:255], v7
  s_mov_b64 exec, 0xffff
  s_andn2_b32 s4, s93, 0x3000
  v_add_u32 v16, 8192, v5
  s_add_u32 s4, s4, s86
  s_add_u32 s6, s6, 65536
  s_cmp_gt_u32 s3, 1
  ds_write2_b64 v16, v[240:241], v[244:245] offset0:0 offset1:32
  s_nop 0
  ds_write2_b64 v16, v[248:249], v[252:253] offset0:64 offset1:96
  s_barrier
  s_mov_b64 exec, -1
  s_cbranch_scc1 L_y8s
L_x8192:
  ds_read_b128 v[240:243], v2 offset:8192
  ds_read_b128 v[244:247], v2 offset:9216
  v_bfe_u32 v18, v2, 4, 4
  v_lshlrev_b32 v17, 4, v18
  v_bfe_u32 v18, v2, 8, 2
  v_lshl_add_u32 v17, v18, 2, v17
  s_waitcnt lgkmcnt(1)
  v_pk_add_f32 v[240:241], v[240:241], v[242:243]
  s_waitcnt lgkmcnt(0)
  v_pk_add_f32 v[244:245], v[244:245], v[246:247]
  v_pk_add_f32 v[240:241], v[240:241], v[244:245]
  v_cvt_pk_bf16_f32 v18, v240, v241
  buffer_store_dword v18, v17, s[16:19], s4 offen sc1
  v_cmp_u_f32 vcc, v240, v241
  s_cbranch_vccnz L_x8192_re
L_x8192_ok:
L_y8r:
  v_mov_b32 v28, v8
  v_mov_b32 v30, v9
  s_waitcnt lgkmcnt(0)
  s_cmp_lt_i32 s64, 0
  s_cselect_b32 s4, s66, s65
  s_andn2_b32 s93, s93, 0x3000
  s_or_b32 s93, s93, s4
  s_sleep 8
  s_mov_b32 s61, 0
  s_add_u32 s4, s93, 4096
  buffer_load_dwordx4 v[56:59], v1, s[16:19], s93 offen sc1
  buffer_load_dwordx4 v[60:63], v1, s[16:19], s4 offen sc1
  s_sleep 4
L_y1:
  buffer_load_dwordx4 v[56:59], v1, s[16:19], s93 offen sc1
  buffer_load_dwordx4 v[60:63], v1, s[16:19], s4 offen sc1
  s_mov_b64 exec, -1
L_y1_w:
  s_waitcnt vmcnt(2)
  v_smfmac_f32_16x16x64_bf16 v[28:31], v[20:23], v[56:63], v7 abid:1
  v_max_u32 v11, v56, v60
  v_cmp_eq_u32 vcc, -1, v11
  v_mov_b64 v[240:241], 0
  v_mov_b64 v[244:245], 0
  v_mov_b64 v[248:249], 0
  v_mov_b64 v[252:253], 0
  s_nop 0
  s_cbranch_vccnz L_y1_re
L_y1_go:
  v_cvt_pk_bf16_f32 v50, v28, v30
  v_cmp_u_f32 vcc, v28, v30
  v_dot2_f32_bf16 v51, v50, s78, 0
  v_mov_b32_dpp v32, v50 row_newbcast:0 row_mask:0xf bank_mask:0xf
  v_mov_b32_dpp v33, v50 row_newbcast:1 row_mask:0xf bank_mask:0xf
  v_mov_b32_dpp v34, v50 row_newbcast:2 row_mask:0xf bank_mask:0xf
  v_mov_b32_dpp v35, v50 row_newbcast:3 row_mask:0xf bank_mask:0xf
  v_mov_b32_dpp v36, v50 row_newbcast:4 row_mask:0xf bank_mask:0xf
  v_dot2_f32_bf16 v52, v50, v50, s79
  v_smfmac_f32_16x16x64_bf16 v[240:243], v[32:35], v[64:71], v7
  s_cbranch_vccnz L_y1_re2
L_y1_ok:
  v_mov_b32_dpp v37, v50 row_newbcast:5 row_mask:0xf bank_mask:0xf
  v_smfmac_f32_16x16x64_bf16 v[244:247], v[32:35], v[72:79], v7
  v_mov_b32_dpp v38, v50 row_newbcast:6 row_mask:0xf bank_mask:0xf
  v_smfmac_f32_16x16x64_bf16 v[248:251], v[32:35], v[80:87], v7
  v_mov_b32_dpp v39, v50 row_newbcast:7 row_mask:0xf bank_mask:0xf
  v_smfmac_f32_16x16x64_bf16 v[252:255], v[32:35], v[88:95], v7
  v_mov_b32_dpp v40, v50 row_newbcast:8 row_mask:0xf bank_mask:0xf
  v_smfmac_f32_16x16x64_bf16 v[240:243], v[36:39], v[96:103], v7
  v_permlane32_swap_b32 v51, v52
  v_mov_b32_dpp v41, v50 row_newbcast:9 row_mask:0xf bank_mask:0xf
  v_smfmac_f32_16x16x64_bf16 v[244:247], v[36:39], v[104:111], v7
  v_mov_b32_dpp v42, v50 row_newbcast:10 row_mask:0xf bank_mask:0xf
  v_smfmac_f32_16x16x64_bf16 v[248:251], v[36:39], v[112:119], v7
  v_add_f32 v51, v51, v52
  v_mov_b32_dpp v43, v50 row_newbcast:11 row_mask:0xf bank_mask:0xf
  v_smfmac_f32_16x16x64_bf16 v[252:255], v[36:39], v[120:127], v7
  v_mov_b32_dpp v44, v50 row_newbcast:12 row_mask:0xf bank_mask:0xf
  v_smfmac_f32_16x16x64_bf16 v[240:243], v[40:43], v[128:135], v7
  v_add_f32_dpp v51, v51, v51 row_ror:8 row_mask:0xf bank_mask:0xf
  v_mov_b32_dpp v45, v50 row_newbcast:13 row_mask:0xf bank_mask:0xf
  v_smfmac_f32_16x16x64_bf16 v[244:247], v[40:43], v[136:143], v7
  v_mov_b32_dpp v46, v50 row_newbcast:14 row_mask:0xf bank_mask:0xf
  v_smfmac_f32_16x16x64_bf16 v[248:251], v[40:43], v[144:151], v7
  v_mov_b32_dpp v47, v50 row_newbcast:15 row_mask:0xf bank_mask:0xf
  v_smfmac_f32_16x16x64_bf16 v[252:255], v[40:43], v[152:159], v7
  v_add_f32_dpp v51, v51, v51 row_ror:4 row_mask:0xf bank_mask:0xf
  v_smfmac_f32_16x16x64_bf16 v[240:243], v[44:47], v[160:167], v7
  v_lshlrev_b32 v8, 16, v50
  v_smfmac_f32_16x16x64_bf16 v[244:247], v[44:47], v[168:175], v7
  v_add_f32_dpp v51, v51, v51 row_ror:2 row_mask:0xf bank_mask:0xf
  v_smfmac_f32_16x16x64_bf16 v[248:251], v[44:47], v[176:183], v7
  v_and_b32 v9, 0xffff0000, v50
  v_smfmac_f32_16x16x64_bf16 v[252:255], v[44:47], v[184:191], v7
  v_add_f32_dpp v51, v51, v51 row_ror:1 row_mask:0xf bank_mask:0xf
  v_add_u32 v11, s92, v2
  v_mov_b32 v53, 0
  v_add_f32_dpp v51, v51, v51 row_bcast:15 row_mask:0xa bank_mask:0xf
  v_mul_f32 v51, 0x3b000000, v51
  ds_write_b32 v5, v51 offset:4096
  s_mov_b64 exec, 0xffff
  ds_write2_b64 v5, v[240:241], v[244:245] offset0:0 offset1:32
  ds_write2_b64 v5, v[248:249], v[252:253] offset0:64 offset1:96
  s_barrier
  s_mov_b64 exec, -1
L_x0:
  ds_read_b128 v[240:243], v53 offset:4352
  ds_read_b128 v[244:247], v53 offset:5376
  ds_read_b128 v[248:251], v2 offset:0
  ds_read_b128 v[252:255], v2 offset:1024
  v_mov_b64 v[28:29], 0
  v_mov_b64 v[16:17], 0
  s_waitcnt vmcnt(0)
  v_mov_b64 v[56:57], 0
  v_mov_b64 v[60:61], 0
  v_mov_b32 v51, 0xc0135761
  ds_read_b128 v[32:35], v11 offset:0
  ds_read_b128 v[36:39], v11 offset:1024
  ds_read_b128 v[40:43], v11 offset:2048
  ds_read_b128 v[44:47], v11 offset:3072
  s_waitcnt lgkmcnt(6)
  v_pk_add_f32 v[240:241], v[240:241], v[242:243]
  v_pk_add_f32 v[244:245], v[244:245], v[246:247]
  v_pk_add_f32 v[240:241], v[240:241], v[244:245]
  v_fma_f32 v241, -v240, v240, v241
  v_rsq_f32 v241, v241
  s_waitcnt lgkmcnt(4)
  v_pk_add_f32 v[248:249], v[248:249], v[250:251]
  v_pk_add_f32 v[252:253], v[252:253], v[254:255]
  v_pk_add_f32 v[248:249], v[248:249], v[252:253]
  v_pk_fma_f32 v[248:249], v[240:241], v[12:13], v[248:249] op_sel_hi:[0,1,1] neg_lo:[1,0,0] neg_hi:[1,0,0]
  v_pk_mul_f32 v[248:249], v[240:241], v[248:249] op_sel:[1,0]
  v_mul_f32 v251, v248, v248
  v_mul_f32 v249, v248, v249
  v_fmac_f32 v51, 0xbdd2d3e8, v251
  v_mul_f32 v250, v51, v248
  v_exp_f32 v250, v250
  v_mov_b32_dpp v251, v249 quad_perm:[1,1,3,3] row_mask:0xf bank_mask:0xf
  v_add_f32 v250, 1.0, v250
  v_rcp_f32 v250, v250
  v_cmp_u_f32 vcc, v249, v249
  v_mul_f32 v248, v249, v250
  v_mul_f32_dpp v251, v250, v251 quad_perm:[1,1,3,3] row_mask:0xf bank_mask:0xf
  v_cvt_pk_bf16_f32 v248, v248, v251
  s_nop 1
  v_mov_b32_dpp v48, v248 row_newbcast:0 row_mask:0xf bank_mask:0xf
  v_mov_b32_dpp v49, v248 row_newbcast:2 row_mask:0xf bank_mask:0xf
  v_mov_b32_dpp v50, v248 row_newbcast:4 row_mask:0xf bank_mask:0xf
  v_mov_b32_dpp v51, v248 row_newbcast:6 row_mask:0xf bank_mask:0xf
  v_mov_b32_dpp v52, v248 row_newbcast:8 row_mask:0xf bank_mask:0xf
  v_mov_b32_dpp v53, v248 row_newbcast:10 row_mask:0xf bank_mask:0xf
  v_smfmac_f32_16x16x64_bf16 v[28:31], v[48:51], v[192:199], v7
  v_mov_b32_dpp v54, v248 row_newbcast:12 row_mask:0xf bank_mask:0xf
  v_smfmac_f32_16x16x64_bf16 v[16:19], v[48:51], v[200:207], v7
  v_mov_b32_dpp v55, v248 row_newbcast:14 row_mask:0xf bank_mask:0xf
  v_smfmac_f32_16x16x64_bf16 v[56:59], v[48:51], v[208:215], v7
  v_smfmac_f32_16x16x64_bf16 v[60:63], v[48:51], v[216:223], v7
  v_smfmac_f32_16x16x64_bf16 v[28:31], v[52:55], v[224:231], v7
  v_smfmac_f32_16x16x64_bf16 v[16:19], v[52:55], v[232:239], v7
  s_waitcnt lgkmcnt(0)
  v_smfmac_f32_16x16x64_bf16 v[56:59], v[52:55], v[32:39], v7
  v_smfmac_f32_16x16x64_bf16 v[60:63], v[52:55], v[40:47], v7
  s_nop 3
  v_cvt_pk_bf16_f32 v252, v28, v29
  v_cvt_pk_bf16_f32 v253, v16, v17
  v_mov_b32 v28, v8
  v_cvt_pk_bf16_f32 v254, v56, v57
  v_mov_b32 v30, v9
  v_cvt_pk_bf16_f32 v255, v60, v61
  buffer_store_dwordx4 v[252:255], v3, s[16:19], s6 offen sc1
  s_cbranch_vccnz L_x0_re
L_x0_ok:
  s_add_u32 s6, s6, 65536
  s_add_u32 s93, s93, 65536
  s_add_u32 s5, s5, 0x80000
  v_mov_b64 v[60:61], 0
  v_mov_b64 v[62:63], 0
  v_bfe_u32 v17, v2, 4, 4
  v_lshlrev_b32 v16, 4, v17
  v_bfe_u32 v17, v2, 8, 2
  v_lshl_add_u32 v16, v17, 2, v16
  s_mul_i32 s61, s3, 8
  s_add_u32 s61, s61, 0
  s_xor_b32 s61, s61, s2
  s_min_u32 s61, s61, 1
  s_and_b32 s4, s99, s61
  s_cbranch_scc0 L_doy2
  s_add_u32 s93, s93, 65536
  s_branch L_next_batch
L_doy2:
  s_lshr_b32 s89, s99, 1
  s_lshl_b32 s89, s89, 10
  s_add_u32 s98, s89, s62
  s_add_u32 s89, s99, 1
  s_bitcmp1_b32 s99, 0
  s_cbranch_scc1 L_fy
  s_mov_b32 s98, 2
  s_sleep 9
  s_mov_b32 s61, 0
L_y2:
  buffer_load_dwordx4 v[32:35], v1, s[16:19], s93 offen sc1
  s_add_u32 s4, s93, 4096
  buffer_load_dwordx4 v[36:39], v1, s[16:19], s4 offen sc1
  s_add_u32 s4, s93, 16384
  buffer_load_dwordx4 v[40:43], v1, s[16:19], s4 offen sc1
  s_add_u32 s4, s93, 20480
  buffer_load_dwordx4 v[44:47], v1, s[16:19], s4 offen sc1
  s_add_u32 s4, s93, 32768
  buffer_load_dwordx4 v[48:51], v1, s[16:19], s4 offen sc1
  s_add_u32 s4, s93, 36864
  buffer_load_dwordx4 v[52:55], v1, s[16:19], s4 offen sc1
  s_add_u32 s4, s93, 49152
  buffer_load_dwordx4 v[56:59], v1, s[16:19], s4 offen sc1
  s_mov_b64 exec, -1
L_y2_w:
  s_waitcnt vmcnt(5)
  v_smfmac_f32_16x16x64_bf16 v[28:31], v[20:23], v[32:39], v7 abid:1
  v_max_u32 v11, v32, v36
  s_waitcnt vmcnt(3)
  v_smfmac_f32_16x16x64_bf16 v[28:31], v[20:23], v[40:47], v7 abid:1
  v_max3_u32 v11, v11, v40, v44
  s_waitcnt vmcnt(1)
  v_smfmac_f32_16x16x64_bf16 v[28:31], v[20:23], v[48:55], v7 abid:1
  v_max3_u32 v11, v11, v48, v52
  s_waitcnt vmcnt(0)
  v_smfmac_f32_16x16x64_bf16 v[28:31], v[20:23], v[56:63], v7 abid:1
  v_max3_u32 v11, v11, v56, v60
  v_cmp_eq_u32 vcc, -1, v11
  v_mov_b64 v[240:241], 0
  v_mov_b64 v[244:245], 0
  v_mov_b64 v[248:249], 0
  v_mov_b64 v[252:253], 0
  s_nop 0
  s_cbranch_vccnz L_y2_re
L_y2_go:
  v_cvt_pk_bf16_f32 v50, v28, v30
  v_cmp_u_f32 vcc, v28, v30
L_QG:
  v_dot2_f32_bf16 v51, v50, s78, 0
  v_mov_b32_dpp v32, v50 row_newbcast:0 row_mask:0xf bank_mask:0xf
  v_mov_b32_dpp v33, v50 row_newbcast:1 row_mask:0xf bank_mask:0xf
  v_mov_b32_dpp v34, v50 row_newbcast:2 row_mask:0xf bank_mask:0xf
  v_mov_b32_dpp v35, v50 row_newbcast:3 row_mask:0xf bank_mask:0xf
  v_mov_b32_dpp v36, v50 row_newbcast:4 row_mask:0xf bank_mask:0xf
  v_dot2_f32_bf16 v52, v50, v50, s79
  v_smfmac_f32_16x16x64_bf16 v[240:243], v[32:35], a[0:7], v7
  s_cbranch_vccnz L_y2_re2
L_y2_ok:
  v_mov_b32_dpp v37, v50 row_newbcast:5 row_mask:0xf bank_mask:0xf
  v_smfmac_f32_16x16x64_bf16 v[244:247], v[32:35], a[8:15], v7
  v_mov_b32_dpp v38, v50 row_newbcast:6 row_mask:0xf bank_mask:0xf
  v_smfmac_f32_16x16x64_bf16 v[248:251], v[32:35], a[16:23], v7
  v_mov_b32_dpp v39, v50 row_newbcast:7 row_mask:0xf bank_mask:0xf
  v_smfmac_f32_16x16x64_bf16 v[252:255], v[32:35], a[24:31], v7
  v_mov_b32_dpp v40, v50 row_newbcast:8 row_mask:0xf bank_mask:0xf
  v_smfmac_f32_16x16x64_bf16 v[240:243], v[36:39], a[32:39], v7
  v_permlane32_swap_b32 v51, v52
  v_mov_b32_dpp v41, v50 row_newbcast:9 row_mask:0xf bank_mask:0xf
  v_smfmac_f32_16x16x64_bf16 v[244:247], v[36:39], a[40:47], v7
  v_mov_b32_dpp v42, v50 row_newbcast:10 row_mask:0xf bank_mask:0xf
  v_smfmac_f32_16x16x64_bf16 v[248:251], v[36:39], a[48:55], v7
  v_add_f32 v51, v51, v52
  v_mov_b32_dpp v43, v50 row_newbcast:11 row_mask:0xf bank_mask:0xf
  v_smfmac_f32_16x16x64_bf16 v[252:255], v[36:39], a[56:63], v7
  v_mov_b32_dpp v44, v50 row_newbcast:12 row_mask:0xf bank_mask:0xf
  v_smfmac_f32_16x16x64_bf16 v[240:243], v[40:43], a[64:71], v7
  v_add_f32_dpp v51, v51, v51 row_ror:8 row_mask:0xf bank_mask:0xf
  v_mov_b32_dpp v45, v50 row_newbcast:13 row_mask:0xf bank_mask:0xf
  v_smfmac_f32_16x16x64_bf16 v[244:247], v[40:43], a[72:79], v7
  v_mov_b32_dpp v46, v50 row_newbcast:14 row_mask:0xf bank_mask:0xf
  v_smfmac_f32_16x16x64_bf16 v[248:251], v[40:43], a[80:87], v7
  v_mov_b32_dpp v47, v50 row_newbcast:15 row_mask:0xf bank_mask:0xf
  v_smfmac_f32_16x16x64_bf16 v[252:255], v[40:43], a[88:95], v7
  v_add_f32_dpp v51, v51, v51 row_ror:4 row_mask:0xf bank_mask:0xf
  v_smfmac_f32_16x16x64_bf16 v[240:243], v[44:47], a[96:103], v7
  v_lshlrev_b32 v8, 16, v50
  v_smfmac_f32_16x16x64_bf16 v[244:247], v[44:47], a[104:111], v7
  v_add_f32_dpp v51, v51, v51 row_ror:2 row_mask:0xf bank_mask:0xf
  v_smfmac_f32_16x16x64_bf16 v[248:251], v[44:47], a[112:119], v7
  v_and_b32 v9, 0xffff0000, v50
  v_smfmac_f32_16x16x64_bf16 v[252:255], v[44:47], a[120:127], v7
  v_add_f32_dpp v51, v51, v51 row_ror:1 row_mask:0xf bank_mask:0xf
  s_add_u32 s93, s93, 65536
  v_mov_b32 v53, 0
  v_add_f32_dpp v51, v51, v51 row_bcast:15 row_mask:0xa bank_mask:0xf
  v_mul_f32 v51, 0x3b000000, v51
  ds_write_b32 v5, v51 offset:6144
  s_mov_b64 exec, 0xffff
  ds_write2_b64 v6, v[240:241], v[244:245] offset0:0 offset1:16
  ds_write2_b64 v6, v[248:249], v[252:253] offset0:2 offset1:18
  s_barrier
  s_mov_b64 exec, -1
L_x2048:
  ds_read_b128 v[240:243], v53 offset:6400
  ds_read_b128 v[244:247], v53 offset:7424
  ds_read_b128 v[248:251], v2 offset:2048
  ds_read_b128 v[252:255], v2 offset:3072
  s_lshl_b32 s95, s89, 13
  s_add_u32 s95, s95, s7
  s_mul_i32 s4, s3, 0x10000
  s_add_u32 s95, s95, s4
  v_lshrrev_b32 v11, 2, v2
  s_cmp_eq_u32 s3, 1
  s_waitcnt lgkmcnt(2)
  v_pk_add_f32 v[240:241], v[240:241], v[242:243]
  v_pk_add_f32 v[244:245], v[244:245], v[246:247]
  v_pk_add_f32 v[240:241], v[240:241], v[244:245]
  v_fma_f32 v241, -v240, v240, v241
  v_rsq_f32 v241, v241
  s_waitcnt lgkmcnt(0)
  v_pk_add_f32 v[248:249], v[248:249], v[250:251]
  v_pk_add_f32 v[252:253], v[252:253], v[254:255]
  v_pk_add_f32 v[248:249], v[248:249], v[252:253]
  v_pk_fma_f32 v[248:249], v[240:241], v[14:15], v[248:249] op_sel_hi:[0,1,1] neg_lo:[1,0,0] neg_hi:[1,0,0]
  v_pk_mul_f32 v[248:249], v[240:241], v[248:249] op_sel:[1,0]
  v_cmp_o_f32 vcc, v248, v249
  v_cvt_pk_bf16_f32 v248, v248, v249
  s_cbranch_scc0 L_qn1
  v_cndmask_b32 v248, -1, v248, vcc
  buffer_store_dword v248, v11, s[16:19], s95 offen
L_qdone:
  v_cmp_eq_u32 vcc, -1, v248
  s_cbranch_vccnz L_x2048_re
L_x2048_ok:
  s_lshr_b32 s4, s89, 1
  s_lshl_b32 s4, s4, 10
  s_add_u32 s4, s4, s62
  v_add_u32 v249, s4, v11
  ds_write_b32 v249, v248 offset:10240
  s_waitcnt lgkmcnt(0)
  s_cmp_eq_u32 s98, 0
  s_cbranch_scc1 L_qret0
  s_cmp_eq_u32 s98, 1
  s_cbranch_scc1 L_qret1
L_A:
  s_lshr_b32 s4, s89, 1
  s_lshl_b32 s61, s4, 16
  s_add_u32 s61, s61, s88
  s_lshl_b32 s4, s4, 10
  s_add_u32 s4, s4, s62
  v_bfe_u32 v17, v2, 8, 2
  v_lshl_add_u32 v16, v17, 6, s4
  v_bfe_u32 v17, v2, 4, 2
  v_lshl_add_u32 v16, v17, 4, v16
  ds_read_b128 v[28:31], v16 offset:10240
  v_add_u32 v16, s61, v2
  ds_read_b128 v[48:51], v16 offset:0
  ds_read_b128 v[52:55], v16 offset:1024
  ds_read_b128 v[56:59], v16 offset:2048
  ds_read_b128 v[60:63], v16 offset:3072
  v_bfe_u32 v11, v2, 5, 1
  v_mul_u32_u24 v11, 0xaaaa, v11
  v_add_u32 v11, 0x4444, v11
  v_bfe_u32 v17, v2, 4, 2
  v_mul_u32_u24 v17, 0x5555, v17
  v_lshl_add_u32 v11, v17, 16, v11
  v_mov_b32 v17, 0xff800000
  s_waitcnt lgkmcnt(4)
  v_cndmask_b32 v32, 0, v28, s[52:53]
  v_cndmask_b32 v33, 0, v29, s[52:53]
  v_cndmask_b32 v34, 0, v30, s[52:53]
  v_cndmask_b32 v35, 0, v31, s[52:53]
  v_cndmask_b32 v36, 0, v28, s[54:55]
  v_cndmask_b32 v37, 0, v29, s[54:55]
  v_cndmask_b32 v38, 0, v30, s[54:55]
  v_cndmask_b32 v39, 0, v31, s[54:55]
  v_cndmask_b32 v40, 0, v28, s[56:57]
  v_cndmask_b32 v41, 0, v29, s[56:57]
  v_cndmask_b32 v42, 0, v30, s[56:57]
  v_cndmask_b32 v43, 0, v31, s[56:57]
  v_cndmask_b32 v44, 0, v28, s[58:59]
  v_cndmask_b32 v45, 0, v29, s[58:59]
  v_cndmask_b32 v46, 0, v30, s[58:59]
  v_cndmask_b32 v47, 0, v31, s[58:59]
  v_mov_b64 v[28:29], 0
  v_mov_b64 v[30:31], 0
  s_waitcnt lgkmcnt(2)
  s_nop 0
  v_smfmac_f32_16x16x64_bf16 v[28:31], v[32:35], v[48:55], v11
  ds_read_b128 v[48:51], v16 offset:8192
  ds_read_b128 v[52:55], v16 offset:9216
  s_waitcnt lgkmcnt(2)
  v_smfmac_f32_16x16x64_bf16 v[28:31], v[36:39], v[56:63], v11
  ds_read_b128 v[56:59], v16 offset:10240
  ds_read_b128 v[60:63], v16 offset:11264
  s_waitcnt lgkmcnt(2)
  v_smfmac_f32_16x16x64_bf16 v[28:31], v[40:43], v[48:55], v11
  ds_read_b128 v[48:51], v16 offset:4096
  ds_read_b128 v[52:55], v16 offset:5120
  s_waitcnt lgkmcnt(2)
  v_smfmac_f32_16x16x64_bf16 v[28:31], v[44:47], v[56:63], v11
  ds_read_b128 v[56:59], v16 offset:6144
  ds_read_b128 v[60:63], v16 offset:7168
  s_lshl_b32 s4, s89, 19
  s_lshl_b32 s61, s2, 14
  s_add_u32 s4, s4, s61
  s_add_u32 s4, s4, s62
  s_add_u32 s4, s4, 0x101c00
  s_nop 0
  v_add_f32 v32, v28, v30
  v_add_f32 v33, v29, v31
  s_nop 1
  v_add_f32_dpp v32, v33, v32 quad_perm:[1,0,3,2] row_mask:0xf bank_mask:0xf
  v_cndmask_b32 v17, v32, v17, s[96:97]
  s_nop 1
  v_max_f32_dpp v18, v17, v17 row_ror:8 row_mask:0xf bank_mask:0xf
  v_mov_b64 v[36:37], 0
  v_mov_b64 v[38:39], 0
  v_max_f32_dpp v18, v18, v18 row_ror:4 row_mask:0xf bank_mask:0xf
  v_mov_b64 v[40:41], 0
  v_mov_b64 v[42:43], 0
  v_max_f32_dpp v18, v18, v18 row_ror:2 row_mask:0xf bank_mask:0xf
  v_lshlrev_b32 v44, 22, v2
  v_and_b32 v44, 0x3c000000, v44
  v_max_f32_dpp v18, v18, v18 row_ror:1 row_mask:0xf bank_mask:0xf
  v_mov_b32 v34, v18
  v_lshrrev_b32 v45, 5, v2
  v_add3_u32 v44, v44, v45, s4
  v_permlane32_swap_b32 v18, v34
  v_max_f32 v18, v18, v34
  v_mov_b32 v34, v18
  v_lshrrev_b32 v45, 2, v2
  s_nop 0
  v_permlane16_swap_b32 v18, v34
  v_max_f32 v18, v18, v34
  v_mul_f32 v18, s60, v18
  v_fma_f32 v17, v17, s60, -v18
  v_exp_f32 v17, v17
  s_nop 0
  v_mov_b32 v19, v17
  v_cvt_pk_bf16_f32 v17, v17, 0
  s_nop 1
  v_mov_b32_dpp v20, v17 quad_perm:[0,0,0,0] row_mask:0xf bank_mask:0x3
  v_mov_b32_dpp v22, v17 quad_perm:[2,2,2,2] row_mask:0xf bank_mask:0x3
  s_nop 0
  v_mov_b32_dpp v21, v20 row_ror:8 row_mask:0xf bank_mask:0xc
  v_mov_b32_dpp v23, v22 row_ror:8 row_mask:0xf bank_mask:0xc
  v_add_f32_dpp v19, v19, v19 row_ror:8 row_mask:0xf bank_mask:0xf
  s_waitcnt lgkmcnt(2)
  v_smfmac_f32_16x16x64_bf16 v[36:39], v[20:23], v[48:55], v11 abid:1
  ds_read_b128 v[48:51], v16 offset:12288
  ds_read_b128 v[52:55], v16 offset:13312
  v_add_f32_dpp v19, v19, v19 row_ror:4 row_mask:0xf bank_mask:0xf
  s_waitcnt lgkmcnt(2)
  v_smfmac_f32_16x16x64_bf16 v[40:43], v[20:23], v[56:63], v11 abid:1
  ds_read_b128 v[56:59], v16 offset:14336
  ds_read_b128 v[60:63], v16 offset:15360
  v_mov_b32_dpp v25, v17 quad_perm:[0,0,0,0] row_mask:0xf bank_mask:0xc
  v_mov_b32_dpp v27, v17 quad_perm:[2,2,2,2] row_mask:0xf bank_mask:0xc
  s_nop 0
  v_mov_b32_dpp v24, v25 row_ror:8 row_mask:0xf bank_mask:0x3
  v_mov_b32_dpp v26, v27 row_ror:8 row_mask:0xf bank_mask:0x3
  v_add_f32_dpp v19, v19, v19 row_ror:2 row_mask:0xf bank_mask:0xf
  s_waitcnt lgkmcnt(2)
  v_smfmac_f32_16x16x64_bf16 v[36:39], v[24:27], v[48:55], v11 abid:1
  v_add_f32_dpp v19, v19, v19 row_ror:1 row_mask:0xf bank_mask:0xf
  s_waitcnt lgkmcnt(0)
  v_smfmac_f32_16x16x64_bf16 v[40:43], v[24:27], v[56:63], v11 abid:1
  s_mul_i32 s61, s3, -224
  s_add_u32 s61, s61, 1920
  s_cmp_lg_u32 s87, 15
  s_nop 3
  s_cbranch_scc1 L_ow0
  buffer_store_dwordx2 v[18:19], v44, s[16:19], s61 offen
L_ow0r:
  v_permlane16_swap_b32 v36, v40
  v_permlane16_swap_b32 v38, v42
  v_permlane16_swap_b32 v37, v41
  v_add_f32_dpp v36, v40, v36 row_ror:8 row_mask:0xf bank_mask:0x3
  v_add_f32_dpp v38, v42, v38 row_ror:8 row_mask:0xf bank_mask:0x3
  v_permlane16_swap_b32 v39, v43
  v_add_f32_dpp v36, v37, v41 row_ror:8 row_mask:0xf bank_mask:0xc
  s_nop 0
  v_add_f32_dpp v38, v39, v43 row_ror:8 row_mask:0xf bank_mask:0xc
  v_cvt_pk_bf16_f32 v36, v36, v38
  s_cmp_lg_u32 s87, 15
  s_cbranch_scc1 L_ow1
  buffer_store_dword v36, v45, s[16:19], s4 offen
L_ow1r:
  s_cmp_eq_u32 s98, 0
  s_cbranch_scc1 L_aret0
  s_add_u32 s99, s99, 1
  s_cmp_lg_u32 s99, 1
  s_cbranch_scc1 L_chain
  v_lshrrev_b32 v51, 4, v2
  v_bfe_u32 v50, v51, 0, 1
  v_lshlrev_b32 v48, 4, v50
  v_bfe_u32 v50, v51, 4, 2
  v_lshl_add_u32 v48, v50, 5, v48
  v_bfe_u32 v50, v51, 1, 2
  v_lshl_add_u32 v48, v50, 8, v48
  v_bfe_u32 v50, v51, 3, 1
  v_lshl_add_u32 v48, v50, 12, v48
  s_add_u32 s4, s63, 0x4000000
  s_add_u32 m0, s88, 65536
  s_nop 0
  buffer_load_dwordx4 v48, s[8:11], s4 offen offset:0 nt lds
  s_add_u32 m0, s88, 66432
  s_nop 0
  buffer_load_dwordx4 v48, s[8:11], s4 offen offset:128 nt lds
  s_add_u32 m0, s88, 66560
  s_nop 0
  buffer_load_dwordx4 v48, s[8:11], s4 offen offset:1024 nt lds
  s_add_u32 m0, s88, 67456
  s_nop 0
  buffer_load_dwordx4 v48, s[8:11], s4 offen offset:1152 nt lds
  s_add_u32 s4, s63, 0x4000800
  s_add_u32 m0, s88, 73728
  s_nop 0
  buffer_load_dwordx4 v48, s[8:11], s4 offen offset:0 nt lds
  s_add_u32 m0, s88, 74624
  s_nop 0
  buffer_load_dwordx4 v48, s[8:11], s4 offen offset:128 nt lds
  s_add_u32 m0, s88, 74752
  s_nop 0
  buffer_load_dwordx4 v48, s[8:11], s4 offen offset:1024 nt lds
  s_add_u32 m0, s88, 75648
  s_nop 0
  buffer_load_dwordx4 v48, s[8:11], s4 offen offset:1152 nt lds
  s_add_u32 s4, s63, 0x4000000
  s_add_u32 m0, s88, 69632
  s_nop 0
  buffer_load_dwordx4 v4, s[12:15], s4 offen offset:0 nt lds
  s_add_u32 m0, s88, 68608
  s_nop 0
  buffer_load_dwordx4 v4, s[12:15], s4 offen offset:2048 nt lds
  s_add_u32 m0, s88, 71552
  s_nop 0
  buffer_load_dwordx4 v4, s[12:15], s4 offen offset:128 nt lds
  s_add_u32 m0, s88, 70528
  s_nop 0
  buffer_load_dwordx4 v4, s[12:15], s4 offen offset:2176 nt lds
  s_add_u32 s4, s63, 0x4001000
  s_add_u32 m0, s88, 77824
  s_nop 0
  buffer_load_dwordx4 v4, s[12:15], s4 offen offset:0 nt lds
  s_add_u32 m0, s88, 76800
  s_nop 0
  buffer_load_dwordx4 v4, s[12:15], s4 offen offset:2048 nt lds
  s_add_u32 m0, s88, 79744
  s_nop 0
  buffer_load_dwordx4 v4, s[12:15], s4 offen offset:128 nt lds
  s_add_u32 m0, s88, 78720
  s_nop 0
  buffer_load_dwordx4 v4, s[12:15], s4 offen offset:2176 nt lds
  s_branch L_chain
L_fy:
  s_sleep 6
  s_mov_b32 s61, 0
  buffer_load_dwordx4 v[32:35], v1, s[16:19], s93 offen sc1
  s_add_u32 s4, s93, 4096
  buffer_load_dwordx4 v[36:39], v1, s[16:19], s4 offen sc1
  s_add_u32 s4, s93, 16384
  buffer_load_dwordx4 v[40:43], v1, s[16:19], s4 offen sc1
  s_add_u32 s4, s93, 20480
  buffer_load_dwordx4 v[44:47], v1, s[16:19], s4 offen sc1
  s_add_u32 s4, s93, 32768
  buffer_load_dwordx4 v[48:51], v1, s[16:19], s4 offen sc1
  s_add_u32 s4, s93, 36864
  buffer_load_dwordx4 v[52:55], v1, s[16:19], s4 offen sc1
  s_add_u32 s4, s93, 49152
  buffer_load_dwordx4 v[56:59], v1, s[16:19], s4 offen sc1
  s_sleep 5
L_y3:
  buffer_load_dwordx4 v[32:35], v1, s[16:19], s93 offen sc1
  s_add_u32 s4, s93, 4096
  buffer_load_dwordx4 v[36:39], v1, s[16:19], s4 offen sc1
  s_add_u32 s4, s93, 16384
  buffer_load_dwordx4 v[40:43], v1, s[16:19], s4 offen sc1
  s_add_u32 s4, s93, 20480
  buffer_load_dwordx4 v[44:47], v1, s[16:19], s4 offen sc1
  s_add_u32 s4, s93, 32768
  buffer_load_dwordx4 v[48:51], v1, s[16:19], s4 offen sc1
  s_add_u32 s4, s93, 36864
  buffer_load_dwordx4 v[52:55], v1, s[16:19], s4 offen sc1
  s_add_u32 s4, s93, 49152
  buffer_load_dwordx4 v[56:59], v1, s[16:19], s4 offen sc1
  s_mov_b64 exec, -1
L_y3_w:
  s_waitcnt vmcnt(12)
  v_smfmac_f32_16x16x64_bf16 v[28:31], v[20:23], v[32:39], v7 abid:1
  v_max_u32 v11, v32, v36
  s_waitcnt vmcnt(10)
  v_smfmac_f32_16x16x64_bf16 v[28:31], v[20:23], v[40:47], v7 abid:1
  v_max3_u32 v11, v11, v40, v44
  s_waitcnt vmcnt(8)
  v_smfmac_f32_16x16x64_bf16 v[28:31], v[20:23], v[48:55], v7 abid:1
  v_max3_u32 v11, v11, v48, v52
  s_waitcnt vmcnt(7)
  v_smfmac_f32_16x16x64_bf16 v[28:31], v[20:23], v[56:63], v7 abid:1
  v_max3_u32 v11, v11, v56, v60
  v_cmp_eq_u32 vcc, -1, v11
  s_nop 4
  s_cbranch_vccnz L_y3_re
L_y3_go:
  v_cvt_pk_bf16_f32 v248, v28, v30
  v_cmp_u_f32 vcc, v28, v30
  buffer_store_dword v248, v16, s[48:51], s98 offen
  s_cbranch_vccnz L_y3_re2
L_y3_ok:
  s_add_u32 s93, s93, 65536
L_next_batch:
  s_cmp_eq_u32 s99, 3
  s_cbranch_scc1 L_end
  buffer_load_dword v8, v16, s[24:27], s62 offen offset:1024
  s_waitcnt vmcnt(0)
  v_and_b32 v9, 0xffff0000, v8
  v_lshlrev_b32 v8, 16, v8
  s_mov_b32 s89, 2
  s_mov_b32 s98, 2
  s_branch L_A
L_wm:
  s_add_u32 s4, s5, 0x80000
  buffer_load_dword v32, v10, s[16:19], s4 offen sc1
  s_lshr_b32 s95, s2, 3
  s_lshl_b32 s95, s95, 11
  s_add_u32 s4, s4, s95
  buffer_load_dword v32, v2, s[16:19], s4 offen offset:0 sc1
  buffer_load_dword v32, v2, s[16:19], s4 offen offset:1024 sc1
  s_branch L_wmr
L_ml_re:
  s_add_u32 s61, s61, 1
  s_cmp_gt_u32 s61, 20000
  s_cbranch_scc1 L_ml_go
  s_sleep 1
  s_branch L_ml
L_rp_re:
  v_max_u32 v11, v32, v40
  v_cmp_eq_u32 s[68:69], -1, v11
  v_max_u32 v11, v36, v44
  v_cmp_eq_u32 s[70:71], -1, v11
  v_max_u32 v11, v48, v56
  v_cmp_eq_u32 s[72:73], -1, v11
  v_max_u32 v11, v52, v60
  v_cmp_eq_u32 s[74:75], -1, v11
  s_mov_b64 exec, s[68:69]
  s_cbranch_execz L_rp_s0
  buffer_load_dwordx4 v[32:35], v4, s[16:19], s5 offen offset:0 sc1
  buffer_load_dwordx4 v[40:43], v4, s[16:19], s5 offen offset:128 sc1
L_rp_s0:
  s_mov_b64 exec, s[70:71]
  s_cbranch_execz L_rp_s1
  buffer_load_dwordx4 v[36:39], v4, s[16:19], s5 offen offset:2048 sc1
  buffer_load_dwordx4 v[44:47], v4, s[16:19], s5 offen offset:2176 sc1
L_rp_s1:
  s_mov_b64 exec, s[72:73]
  s_cbranch_execz L_rp_s2
  buffer_load_dwordx4 v[48:51], v4, s[16:19], s94 offen offset:0 sc1
  buffer_load_dwordx4 v[56:59], v4, s[16:19], s94 offen offset:128 sc1
L_rp_s2:
  s_mov_b64 exec, s[74:75]
  s_cbranch_execz L_rp_s3
  buffer_load_dwordx4 v[52:55], v4, s[16:19], s94 offen offset:2048 sc1
  buffer_load_dwordx4 v[60:63], v4, s[16:19], s94 offen offset:2176 sc1
L_rp_s3:
  s_mov_b64 exec, -1
  v_mov_b64 v[28:29], 0
  v_mov_b64 v[30:31], 0
  v_mov_b64 v[16:17], 0
  v_mov_b64 v[18:19], 0
  s_add_u32 s61, s61, 1
  s_cmp_gt_u32 s61, 20000
  s_cbranch_scc1 L_rp_go
  s_waitcnt vmcnt(0)
  v_smfmac_f32_16x16x64_bf16 v[28:31], v[20:23], v[32:39], v7 abid:1
  v_max_u32 v11, v32, v36
  v_smfmac_f32_16x16x64_bf16 v[16:19], v[20:23], v[40:47], v7 abid:1
  v_max3_u32 v11, v11, v40, v44
  v_smfmac_f32_16x16x64_bf16 v[28:31], v[24:27], v[48:55], v7 abid:1
  v_max3_u32 v11, v11, v48, v52
  v_smfmac_f32_16x16x64_bf16 v[16:19], v[24:27], v[56:63], v7 abid:1
  v_max3_u32 v11, v11, v56, v60
  v_cmp_eq_u32 vcc, -1, v11
  s_nop 3
  v_add_f32_dpp v28, v29, v28 row_ror:8 row_mask:0xf bank_mask:0x3
  v_add_f32_dpp v30, v31, v30 row_ror:8 row_mask:0xf bank_mask:0x3
  s_nop 0
  s_cbranch_vccz L_rp_go
  s_branch L_rp_re
L_rp_re2:
  s_add_u32 s61, s61, 1
  s_cmp_gt_u32 s61, 20000
  s_cbranch_scc1 L_rp_ok
  v_mov_b64 v[28:29], 0
  v_mov_b64 v[30:31], 0
  v_mov_b64 v[16:17], 0
  v_mov_b64 v[18:19], 0
  s_nop 0
  s_branch L_rp
L_x8192_re:
  v_mov_b32 v53, 0
  s_waitcnt vmcnt(0) lgkmcnt(0)
  s_add_u32 s61, s61, 1
  s_cmp_le_u32 s61, 20000
  s_cbranch_scc1 L_x8192
  s_cmp_eq_u32 s3, 1
  s_branch L_x8192_ok
L_y8s:
  s_sleep 1
  s_branch L_y8r
L_y1_re:
  s_add_u32 s61, s61, 1
  s_cmp_gt_u32 s61, 20000
  s_cbranch_scc1 L_y1_go
  v_mov_b32 v28, v8
  v_mov_b32 v30, v9
  s_mov_b64 exec, vcc
  s_branch L_y1
L_y1_re2:
  s_add_u32 s61, s61, 1
  s_cmp_gt_u32 s61, 20000
  s_cbranch_scc1 L_y1_ok
  v_mov_b32 v28, v8
  v_mov_b32 v30, v9
  s_nop 0
  s_branch L_y1
L_x0_re:
  v_mov_b32 v53, 0
  s_waitcnt vmcnt(0) lgkmcnt(0)
  s_add_u32 s61, s61, 1
  s_cmp_le_u32 s61, 20000
  s_cbranch_scc1 L_x0
  s_cmp_eq_u32 s3, 1
  s_branch L_x0_ok
L_y2_re:
  s_add_u32 s61, s61, 1
  s_cmp_gt_u32 s61, 20000
  s_cbranch_scc1 L_y2_go
  v_mov_b32 v28, v8
  v_mov_b32 v30, v9
  s_mov_b64 exec, vcc
  s_branch L_y2
L_y2_re2:
  s_add_u32 s61, s61, 1
  s_cmp_gt_u32 s61, 20000
  s_cbranch_scc1 L_y2_ok
  v_mov_b32 v28, v8
  v_mov_b32 v30, v9
  s_nop 0
  s_branch L_y2
L_x2048_re:
  v_mov_b32 v53, 0
  s_waitcnt vmcnt(0) lgkmcnt(0)
  s_add_u32 s61, s61, 1
  s_cmp_le_u32 s61, 20000
  s_cbranch_scc1 L_x2048
  s_cmp_eq_u32 s3, 1
  s_branch L_x2048_ok
L_qn1:
  s_cmp_lg_u32 s3, 0
  v_cndmask_b32 v248, -1, v248, vcc
  s_nop 0
  s_cbranch_scc1 L_qdone
  buffer_store_dword v248, v11, s[16:19], s95 offen sc1
  s_branch L_qdone
L_ow0:
  buffer_store_dwordx2 v[18:19], v44, s[16:19], s61 offen sc1
  s_branch L_ow0r
L_ow1:
  buffer_store_dword v36, v45, s[16:19], s4 offen sc1
  s_branch L_ow1r
L_y3_re:
  s_add_u32 s61, s61, 1
  s_cmp_gt_u32 s61, 20000
  s_cbranch_scc1 L_y3_go
  v_mov_b32 v28, v8
  v_mov_b32 v30, v9
  s_mov_b64 exec, vcc
  s_branch L_y3
L_y3_re2:
  s_add_u32 s61, s61, 1
  s_cmp_gt_u32 s61, 20000
  s_cbranch_scc1 L_y3_ok
  v_mov_b32 v28, v8
  v_mov_b32 v30, v9
  s_nop 0
  s_branch L_y3
L_end:
  s_endpgm
.section .rodata,"a"
.p2align 6
.amdhsa_kernel interleave_layers__mha_block_cached__glu_gated_geglu__decode_kernel
  .amdhsa_next_free_vgpr 512
  .amdhsa_next_free_sgpr 102
  .amdhsa_accum_offset 256
  .amdhsa_group_segment_fixed_size 0
  .amdhsa_kernarg_size 96
  .amdhsa_user_sgpr_count 2
  .amdhsa_user_sgpr_kernarg_segment_ptr 1
  .amdhsa_system_sgpr_workgroup_id_x 1
.end_amdhsa_kernel
```
